```python
import torch

def _softmax(x, axis=-1):
    return torch.softmax(x, dim=axis)
def _gelu(x):
    return torch.nn.functional.gelu(x, approximate="tanh")
def _silu(x):
    return torch.nn.functional.silu(x)
def _sigmoid(x):
    return torch.sigmoid(x)
def _layernorm(x, axis=-1, eps=1e-5):
    m = x.mean(dim=axis, keepdim=True)
    v = x.var(dim=axis, keepdim=True, unbiased=False)
    return (x - m) / torch.sqrt(v + eps)
def _scatter_add(tgt, idx, src, axis=0):
    return tgt.clone().index_add_(axis, idx, src)
def _segment_sum(src, seg, n):
    out = torch.zeros((n,) + src.shape[1:], dtype=src.dtype)
    return out.index_add_(0, seg, src)
def _pad(x, pw):
    flat = tuple(v for pair in reversed(pw) for v in pair)
    return torch.nn.functional.pad(x, flat)

kernel_name = 'parallel_sum__grouped_kv_mqa__mixer_channel_mlp__prompt'

def setup_inputs():

    _w = (lambda a: (lambda t: t.to(torch.bfloat16) if t.is_floating_point() else t)(torch.as_tensor(a)))
    def _A_setup():
        B, S, D, H = 1, 2048, 1024, 32
        Dh = D // H
        return {
            "x": _w((lambda *s: torch.randn(*s, dtype=torch.bfloat16) * 0.05)(B, S, D)),
            "wq": _w((lambda *s: torch.randn(*s, dtype=torch.bfloat16) * 0.05)(D, H * Dh)),
            "wk": _w((lambda *s: torch.randn(*s, dtype=torch.bfloat16) * 0.05)(D, Dh)),
            "wv": _w((lambda *s: torch.randn(*s, dtype=torch.bfloat16) * 0.05)(D, Dh)),
            "wo": _w((lambda *s: torch.randn(*s, dtype=torch.bfloat16) * 0.05)(H * Dh, D)),
        }
    _A_in = _A_setup()

    def _B_setup():
        B, S, D, F = 1, 2048, 1024, 3584
        return {
            "x": _w((lambda *s: torch.randn(*s, dtype=torch.bfloat16) * 0.05)(B, S, D)),
            "w1": _w((lambda *s: torch.randn(*s, dtype=torch.bfloat16) * 3.2)(D, F) * (D ** -0.5)),
            "b1": _w((lambda *s: torch.randn(*s, dtype=torch.bfloat16) * 1.6)(F)),
            "w2": _w((lambda *s: torch.randn(*s, dtype=torch.bfloat16) * 0.4)(F, D) * (F ** -0.5)),
            "b2": _w((lambda *s: torch.randn(*s, dtype=torch.bfloat16) * 0.8)(D)),
        }
    _B_in = _B_setup()

    return {
        "A_x": _A_in["x"],
        "A_wq": _A_in["wq"],
        "A_wk": _A_in["wk"],
        "A_wv": _A_in["wv"],
        "A_wo": _A_in["wo"],
        "B_x": _B_in["x"],
        "B_w1": _B_in["w1"],
        "B_b1": _B_in["b1"],
        "B_w2": _B_in["w2"],
        "B_b2": _B_in["b2"],
    }

def reference(A_x, A_wq, A_wk, A_wv, A_wo, B_x, B_w1, B_b1, B_w2, B_b2):
    def _A_ref(x, wq, wk, wv, wo):
        B, S, D = x.shape
        H = 32
        Dh = D // H
        q = (lambda x, *d: x.permute(*d))((x @ wq).reshape(B, S, H, Dh), 0, 2, 1, 3)
        k = x @ wk
        v = x @ wv
        scores = torch.einsum("bhqd,bkd->bhqk", q, k) * (Dh ** -0.5)
        p = _softmax(scores, axis=-1)
        o = torch.einsum("bhqk,bkd->bhqd", p, v)
        return (lambda x, *d: x.permute(*d))(o, 0, 2, 1, 3).reshape(B, S, H * Dh) @ wo

    def _B_ref(x, w1, b1, w2, b2):
        y = _layernorm(x, axis=-1)
        h = _gelu(torch.einsum("bsd,df->bsf", y, w1) + b1)
        return torch.einsum("bsf,fd->bsd", h, w2) + b2

    x = A_x
    xn = _layernorm(x, axis=-1)
    return x + _A_ref(xn, A_wq, A_wk, A_wv, A_wo) + _B_ref(xn, B_w1, B_b1, B_w2, B_b2)
```

```asm
; @launch grid=(256,1,1) block=(512,1,1) lds=163840
.amdgcn_target "amdgcn-amd-amdhsa--gfx950"
.text
.globl parallel_sum__grouped_kv_mqa__mixer_channel_mlp__prompt_kernel
.p2align 8
.type parallel_sum__grouped_kv_mqa__mixer_channel_mlp__prompt_kernel,@function
parallel_sum__grouped_kv_mqa__mixer_channel_mlp__prompt_kernel:
    s_cmp_ge_u32 s2, 256
    s_cbranch_scc1 L_end
    s_load_dwordx4 s[64:67], s[0:1], 0
    s_load_dwordx4 s[8:11], s[0:1], 48
    s_load_dwordx2 s[6:7], s[0:1], 96
    s_load_dwordx4 s[32:35], s[0:1], 16
    s_load_dwordx2 s[62:63], s[0:1], 88
    v_and_b32 v1, 63, v0
    v_lshrrev_b32 v2, 6, v0
    s_nop 0
    v_readfirstlane_b32 s40, v2
    v_lshlrev_b32 v5, 4, v1
    s_and_b32 s41, s2, 1
    s_lshl_b32 s41, s41, 3
    s_bfe_u32 s68, s2, 0x30003
    s_add_u32 s41, s41, s68
    s_bfe_u32 s42, s2, 0x20001
    s_lshl_b32 s42, s42, 2
    s_lshr_b32 s43, s2, 6
    s_add_u32 s42, s42, s43
    s_add_u32 s68, s68, s43
    s_lshl_b32 s36, s41, 4
    s_add_u32 s36, s36, s42
    v_and_b32 v3, 15, v1
    v_lshrrev_b32 v4, 4, v1
    v_and_b32 v255, 3, v1
    v_lshlrev_b32 v255, 2, v255
    v_add_u32 v255, 160256, v255
    s_cmp_ge_u32 s40, 4
    s_cbranch_scc1 L_G
    v_lshrrev_b32 v6, 3, v1
    v_and_b32 v7, 7, v1
    v_xor_b32 v7, v7, v6
    v_lshlrev_b32 v7, 4, v7
    v_lshl_add_u32 v6, v6, 11, v7
    s_lshl_b32 s46, s41, 2
    s_add_u32 s46, s46, s40
    s_lshl_b32 s46, s46, 16
    v_add_u32 v6, s46, v6
    s_and_b32 s46, s41, 8
    v_add_u32 v7, 0x4000, v6
    v_add_u32 v14, 0x8000, v6
    v_add_u32 v15, 0xc000, v6
    v_lshrrev_b32 v8, 5, v1
    v_lshlrev_b32 v8, 1, v8
    v_and_b32 v9, 3, v1
    v_xor_b32 v8, v8, v9
    v_lshlrev_b32 v8, 4, v8
    v_lshrrev_b32 v9, 2, v1
    s_lshl_b32 s47, s40, 4
    v_add_u32 v9, s47, v9
    v_mul_u32_u24 v10, 7168, v9
    s_mul_i32 s47, s42, 448
    v_add3_u32 v10, v10, v8, s47
    v_lshl_add_u32 v9, v9, 11, v8
    s_lshl_b32 s47, s42, 7
    v_add_u32 v9, s47, v9
    s_lshl_b32 s51, s40, 12
    s_lshl_b32 s52, s40, 10
    s_add_u32 s52, s52, 16384
    v_lshrrev_b32 v204, 5, v1
    v_and_b32 v205, 31, v1
    v_lshlrev_b32 v205, 4, v205
    v_lshl_add_u32 v205, v204, 11, v205
    s_lshl_b32 s37, s36, 2
    s_add_u32 s37, s37, s40
    s_lshl_b32 s50, s37, 6
    s_add_u32 s50, s50, 0x400000
    s_lshl_b32 s37, s37, 12
    v_lshlrev_b32 v206, 5, v204
    s_add_u32 s69, 0, s68
    s_and_b32 s69, s69, 3
    s_cselect_b32 s69, 0, 4
    s_add_u32 s69, s69, 0
    s_add_u32 s69, s69, s46
    s_and_b32 s69, s69, 15
    s_lshl_b32 s53, s69, 7
    s_lshl_b32 s54, s69, 17
    s_mul_i32 s55, s69, 458752
    s_add_u32 s56, s51, 0
    s_add_u32 s57, s52, 0
    s_waitcnt lgkmcnt(0)
    s_mov_b32 s12, s64
    s_and_b32 s13, s65, 0xffff
    s_mov_b32 s14, 0x400000
    s_mov_b32 s15, 0x20000
    s_add_u32 m0, s56, 0
    s_nop 0
    buffer_load_dwordx4 v6, s[12:15], s53 offen lds
    s_add_u32 m0, s56, 1024
    s_nop 0
    buffer_load_dwordx4 v7, s[12:15], s53 offen lds
    s_add_u32 m0, s56, 2048
    s_nop 0
    buffer_load_dwordx4 v14, s[12:15], s53 offen lds
    s_add_u32 m0, s56, 3072
    s_nop 0
    buffer_load_dwordx4 v15, s[12:15], s53 offen lds
    s_mov_b32 s16, s66
    s_and_b32 s17, s67, 0xffff
    s_mov_b32 s18, 0x200000
    s_mov_b32 s19, 0x20000
    s_add_u32 m0, s57, 0
    s_nop 0
    buffer_load_dwordx4 v9, s[16:19], s54 offen offset:0 lds
    s_add_u32 m0, s57, 16320
    s_nop 0
    buffer_load_dwordx4 v9, s[16:19], s54 offen offset:64 lds
    s_mov_b32 s20, s8
    s_and_b32 s21, s9, 0xffff
    s_mov_b32 s22, 0x700000
    s_mov_b32 s23, 0x20000
    s_add_u32 m0, s57, 4096
    s_nop 0
    buffer_load_dwordx4 v10, s[20:23], s55 offen offset:0 lds
    s_add_u32 m0, s57, 8128
    s_nop 0
    buffer_load_dwordx4 v10, s[20:23], s55 offen offset:64 lds
    s_add_u32 m0, s57, 12160
    s_nop 0
    buffer_load_dwordx4 v10, s[20:23], s55 offen offset:128 lds
    s_add_u32 m0, s57, 32576
    s_nop 0
    buffer_load_dwordx4 v10, s[20:23], s55 offen offset:192 lds
    s_add_u32 m0, s57, 20224
    s_nop 0
    buffer_load_dwordx4 v10, s[20:23], s55 offen offset:256 lds
    s_add_u32 m0, s57, 24256
    s_nop 0
    buffer_load_dwordx4 v10, s[20:23], s55 offen offset:320 lds
    s_add_u32 m0, s57, 28288
    s_nop 0
    buffer_load_dwordx4 v10, s[20:23], s55 offen offset:384 lds
    s_mov_b32 s24, s6
    s_and_b32 s25, s7, 0xffff
    s_mov_b32 s26, 0x10000000
    s_mov_b32 s27, 0x20000
    s_add_u32 s69, 1, s68
    s_and_b32 s69, s69, 3
    s_cselect_b32 s69, 0, 4
    s_add_u32 s69, s69, 1
    s_add_u32 s69, s69, s46
    s_and_b32 s69, s69, 15
    s_lshl_b32 s53, s69, 7
    s_lshl_b32 s54, s69, 17
    s_mul_i32 s55, s69, 458752
    s_add_u32 s56, s51, 53248
    s_add_u32 s57, s52, 53248
    s_add_u32 m0, s56, 0
    s_nop 0
    buffer_load_dwordx4 v6, s[12:15], s53 offen lds
    s_sub_u32 s43, 9, s68
    s_and_b32 s43, s43, 7
    v_lshrrev_b32 v207, 2, v1
    v_lshl_add_u32 v207, v207, 6, v8
    s_add_u32 m0, s56, 1024
    s_nop 0
    buffer_load_dwordx4 v7, s[12:15], s53 offen lds
    s_add_u32 s47, s51, 16384
    v_add_u32 v222, s47, v207
    v_add_u32 v223, 49152, v207
    v_lshrrev_b32 v208, 1, v3
    s_add_u32 m0, s56, 2048
    s_nop 0
    buffer_load_dwordx4 v14, s[12:15], s53 offen lds
    v_and_b32 v209, 1, v3
    v_lshlrev_b32 v209, 4, v209
    v_mov_b32 v210, 0x3f80
    v_lshlrev_b32 v209, v209, v210
    s_add_u32 m0, s56, 3072
    s_nop 0
    buffer_load_dwordx4 v15, s[12:15], s53 offen lds
    v_cmp_eq_u32 vcc, 0, v208
    s_nop 1
    v_cndmask_b32 v196, 0, v209, vcc
    v_cmp_eq_u32 vcc, 1, v208
    s_nop 1
    v_cndmask_b32 v197, 0, v209, vcc
    v_cmp_eq_u32 vcc, 2, v208
    s_nop 1
    v_cndmask_b32 v198, 0, v209, vcc
    v_cmp_eq_u32 vcc, 3, v208
    s_nop 1
    v_cndmask_b32 v199, 0, v209, vcc
    s_add_u32 m0, s57, 0
    s_nop 0
    buffer_load_dwordx4 v9, s[16:19], s54 offen offset:0 lds
    s_and_b32 s44, s42, 3
    s_cmp_ge_u32 s44, 2
    s_cselect_b32 s32, s34, s32
    s_cselect_b32 s33, s35, s33
    s_cselect_b32 s47, 4, 5
    s_cselect_b32 s48, 5, 4
    s_and_b32 s33, s33, 0xffff
    s_mov_b32 s34, 0x10000
    s_add_u32 m0, s57, 16320
    s_nop 0
    buffer_load_dwordx4 v9, s[16:19], s54 offen offset:64 lds
    s_mov_b32 s35, 0x20000
    v_and_b32 v11, 1, v1
    v_lshlrev_b32 v11, s47, v11
    v_bfe_u32 v12, v1, 1, 3
    s_add_u32 m0, s57, 4096
    s_nop 0
    buffer_load_dwordx4 v10, s[20:23], s55 offen offset:0 lds
    v_lshl_add_u32 v11, v12, 6, v11
    v_lshl_add_u32 v11, v4, 11, v11
    s_and_b32 s47, s44, 1
    s_lshl_b32 s47, s47, s48
    s_add_u32 m0, s57, 8128
    s_nop 0
    buffer_load_dwordx4 v10, s[20:23], s55 offen offset:64 lds
    s_lshl_b32 s60, s40, 14
    s_add_u32 s60, s60, s47
    s_lshl_b32 s45, s41, 2
    s_lshr_b32 s47, s42, 2
    s_add_u32 m0, s57, 12160
    s_nop 0
    buffer_load_dwordx4 v10, s[20:23], s55 offen offset:128 lds
    s_add_u32 s45, s45, s47
    s_lshl_b32 s61, s45, 16
    s_lshl_b32 s47, s40, 9
    s_add_u32 s61, s61, s47
    s_add_u32 m0, s57, 32576
    s_nop 0
    buffer_load_dwordx4 v10, s[20:23], s55 offen offset:192 lds
    v_bfe_u32 v211, v1, 2, 2
    v_lshlrev_b32 v211, 13, v211
    v_and_b32 v212, 3, v1
    v_lshl_add_u32 v211, v212, 4, v211
    s_add_u32 m0, s57, 20224
    s_nop 0
    buffer_load_dwordx4 v10, s[20:23], s55 offen offset:256 lds
    v_lshl_add_u32 v211, v4, 6, v211
    s_lshl_b32 s59, s40, 10
    s_add_u32 s59, s59, 159744
    v_lshlrev_b32 v12, 8, v4
    s_add_u32 m0, s57, 24256
    s_nop 0
    buffer_load_dwordx4 v10, s[20:23], s55 offen offset:320 lds
    v_bfe_u32 v13, v1, 2, 2
    v_lshl_add_u32 v12, v13, 5, v12
    v_and_b32 v13, 3, v1
    v_lshl_add_u32 v12, v13, 3, v12
    s_add_u32 m0, s57, 28288
    s_nop 0
    buffer_load_dwordx4 v10, s[20:23], s55 offen offset:384 lds
    v_add_u32 v12, s59, v12
    v_mov_b32 v188, 0x3f803f80
    v_mov_b32 v189, 0x3f803f80
    v_mov_b32 v190, 0x3f803f80
    v_mov_b32 v191, 0x3f803f80
    s_add_u32 s69, 2, s68
    s_and_b32 s69, s69, 3
    s_cselect_b32 s69, 0, 4
    s_add_u32 s69, s69, 2
    s_add_u32 s69, s69, s46
    s_and_b32 s69, s69, 15
    s_lshl_b32 s53, s69, 7
    s_lshl_b32 s54, s69, 17
    s_mul_i32 s55, s69, 458752
    s_add_u32 s56, s51, 106496
    s_add_u32 s57, s52, 106496
    s_waitcnt vmcnt(13)
    s_barrier
    s_mov_b32 s4, s62
    s_mov_b32 s5, s63
    s_add_u32 m0, s56, 0
    s_nop 0
    buffer_load_dwordx4 v6, s[12:15], s53 offen lds
    s_add_u32 m0, s56, 1024
    s_nop 0
    buffer_load_dwordx4 v7, s[12:15], s53 offen lds
    s_add_u32 m0, s56, 2048
    s_nop 0
    buffer_load_dwordx4 v14, s[12:15], s53 offen lds
    s_add_u32 m0, s56, 3072
    s_nop 0
    buffer_load_dwordx4 v15, s[12:15], s53 offen lds
    s_add_u32 m0, s57, 0
    s_nop 0
    buffer_load_dwordx4 v9, s[16:19], s54 offen offset:0 lds
    s_add_u32 m0, s57, 16320
    s_nop 0
    buffer_load_dwordx4 v9, s[16:19], s54 offen offset:64 lds
    s_add_u32 m0, s57, 4096
    s_nop 0
    buffer_load_dwordx4 v10, s[20:23], s55 offen offset:0 lds
    s_add_u32 m0, s57, 8128
    s_nop 0
    buffer_load_dwordx4 v10, s[20:23], s55 offen offset:64 lds
    s_add_u32 m0, s57, 12160
    s_nop 0
    buffer_load_dwordx4 v10, s[20:23], s55 offen offset:128 lds
    s_add_u32 m0, s57, 32576
    s_nop 0
    buffer_load_dwordx4 v10, s[20:23], s55 offen offset:192 lds
    s_add_u32 m0, s57, 20224
    s_nop 0
    buffer_load_dwordx4 v10, s[20:23], s55 offen offset:256 lds
    s_add_u32 m0, s57, 24256
    s_nop 0
    buffer_load_dwordx4 v10, s[20:23], s55 offen offset:320 lds
    s_add_u32 m0, s57, 28288
    s_nop 0
    buffer_load_dwordx4 v10, s[20:23], s55 offen offset:384 lds
    s_cmp_eq_u32 s43, 0
    s_cbranch_scc0 LA_cn0
    s_mov_b32 s58, 0
    s_call_b64 s[62:63], LA_cs
LA_cn0:
    s_waitcnt vmcnt(13)
    s_waitcnt lgkmcnt(0)
    s_barrier
    s_mov_b32 m0, s59
    s_add_u32 s47, s60, 0
    buffer_load_dwordx4 v11, s[32:35], s47 offen lds
    s_add_u32 s69, 3, s68
    s_and_b32 s69, s69, 3
    s_cselect_b32 s69, 0, 4
    s_add_u32 s69, s69, 3
    s_add_u32 s69, s69, s46
    s_and_b32 s69, s69, 15
    s_lshl_b32 s53, s69, 7
    s_lshl_b32 s54, s69, 17
    s_mul_i32 s55, s69, 458752
    s_add_u32 s56, s51, 0
    s_add_u32 s57, s52, 0
    s_add_u32 m0, s56, 0
    s_nop 0
    buffer_load_dwordx4 v6, s[12:15], s53 offen lds
    buffer_load_dwordx4 v[232:235], v205, s[12:15], s37 offen offset:0
    s_add_u32 m0, s56, 1024
    s_nop 0
    buffer_load_dwordx4 v7, s[12:15], s53 offen lds
    buffer_load_dwordx4 v[236:239], v205, s[12:15], s37 offen offset:512
    buffer_load_dwordx4 v[240:243], v205, s[12:15], s37 offen offset:1024
    s_add_u32 m0, s56, 2048
    s_nop 0
    buffer_load_dwordx4 v14, s[12:15], s53 offen lds
    buffer_load_dwordx4 v[244:247], v205, s[12:15], s37 offen offset:1536
    s_mov_b32 s28, s4
    s_add_u32 m0, s56, 3072
    s_nop 0
    buffer_load_dwordx4 v15, s[12:15], s53 offen lds
    s_and_b32 s29, s5, 0xffff
    s_mov_b32 s30, 0x100
    s_add_u32 m0, s57, 0
    s_nop 0
    buffer_load_dwordx4 v9, s[16:19], s54 offen offset:0 lds
    s_mov_b32 s31, 0x20000
    v_mov_b32 v217, 1
    s_add_u32 m0, s57, 16320
    s_nop 0
    buffer_load_dwordx4 v9, s[16:19], s54 offen offset:64 lds
    v_mov_b32 v219, 0
    v_lshlrev_b32 v216, 2, v1
    s_add_u32 m0, s57, 4096
    s_nop 0
    buffer_load_dwordx4 v10, s[20:23], s55 offen offset:0 lds
    v_lshlrev_b32 v224, 2, v1
    s_add_u32 m0, s57, 8128
    s_nop 0
    buffer_load_dwordx4 v10, s[20:23], s55 offen offset:64 lds
    s_lshl_b32 s64, s41, 12
    s_add_u32 s64, s64, 0x2e00d00
    s_add_u32 m0, s57, 12160
    s_nop 0
    buffer_load_dwordx4 v10, s[20:23], s55 offen offset:128 lds
    s_lshl_b32 s65, s42, 12
    s_add_u32 s65, s65, 0x2e00e00
    s_add_u32 m0, s57, 32576
    s_nop 0
    buffer_load_dwordx4 v10, s[20:23], s55 offen offset:192 lds
    s_lshl_b32 s66, s42, 2
    s_add_u32 s66, s66, s40
    s_add_u32 m0, s57, 20224
    s_nop 0
    buffer_load_dwordx4 v10, s[20:23], s55 offen offset:256 lds
    s_lshl_b32 s66, s66, 2
    s_add_u32 s66, s66, s64
    s_add_u32 m0, s57, 24256
    s_nop 0
    buffer_load_dwordx4 v10, s[20:23], s55 offen offset:320 lds
    s_lshl_b32 s67, s41, 2
    s_add_u32 s67, s67, s40
    s_add_u32 m0, s57, 28288
    s_nop 0
    buffer_load_dwordx4 v10, s[20:23], s55 offen offset:384 lds
    s_lshl_b32 s67, s67, 2
    s_add_u32 s67, s67, s65
    s_cmp_eq_u32 s43, 1
    s_cbranch_scc0 LA_cn1
    s_mov_b32 s58, 53248
    s_call_b64 s[62:63], LA_cs
LA_cn1:
    s_waitcnt vmcnt(18)
    s_waitcnt lgkmcnt(0)
    s_barrier
    s_waitcnt vmcnt(17)
    ds_read_b64_tr_b16 v[96:97], v12
    ds_read_b64_tr_b16 v[98:99], v12 offset:128
    s_waitcnt lgkmcnt(0)
    s_mov_b32 m0, s59
    s_add_u32 s47, s60, 512
    buffer_load_dwordx4 v11, s[32:35], s47 offen lds
    s_add_u32 s69, 4, s68
    s_and_b32 s69, s69, 3
    s_cselect_b32 s69, 0, 4
    s_add_u32 s69, s69, 4
    s_add_u32 s69, s69, s46
    s_and_b32 s69, s69, 15
    s_lshl_b32 s53, s69, 7
    s_lshl_b32 s54, s69, 17
    s_mul_i32 s55, s69, 458752
    s_add_u32 s56, s51, 53248
    s_add_u32 s57, s52, 53248
    s_add_u32 m0, s56, 0
    s_nop 0
    buffer_load_dwordx4 v6, s[12:15], s53 offen lds
    s_waitcnt vmcnt(12)
    v_lshlrev_b32 v16, 16, v232
    v_and_b32 v17, 0xffff0000, v232
    v_lshlrev_b32 v18, 16, v233
    v_and_b32 v19, 0xffff0000, v233
    s_add_u32 m0, s56, 1024
    s_nop 0
    buffer_load_dwordx4 v7, s[12:15], s53 offen lds
    v_lshlrev_b32 v20, 16, v234
    v_and_b32 v21, 0xffff0000, v234
    v_lshlrev_b32 v22, 16, v235
    v_and_b32 v23, 0xffff0000, v235
    v_lshlrev_b32 v24, 16, v236
    v_and_b32 v25, 0xffff0000, v236
    s_add_u32 m0, s56, 2048
    s_nop 0
    buffer_load_dwordx4 v14, s[12:15], s53 offen lds
    v_lshlrev_b32 v26, 16, v237
    v_and_b32 v27, 0xffff0000, v237
    v_lshlrev_b32 v28, 16, v238
    v_and_b32 v29, 0xffff0000, v238
    v_lshlrev_b32 v30, 16, v239
    s_add_u32 m0, s56, 3072
    s_nop 0
    buffer_load_dwordx4 v15, s[12:15], s53 offen lds
    v_and_b32 v31, 0xffff0000, v239
    v_lshlrev_b32 v32, 16, v240
    v_and_b32 v33, 0xffff0000, v240
    v_lshlrev_b32 v34, 16, v241
    v_and_b32 v35, 0xffff0000, v241
    v_lshlrev_b32 v36, 16, v242
    s_add_u32 m0, s57, 0
    s_nop 0
    buffer_load_dwordx4 v9, s[16:19], s54 offen offset:0 lds
    v_and_b32 v37, 0xffff0000, v242
    v_lshlrev_b32 v38, 16, v243
    v_and_b32 v39, 0xffff0000, v243
    v_lshlrev_b32 v40, 16, v244
    v_and_b32 v41, 0xffff0000, v244
    s_add_u32 m0, s57, 16320
    s_nop 0
    buffer_load_dwordx4 v9, s[16:19], s54 offen offset:64 lds
    v_lshlrev_b32 v42, 16, v245
    v_and_b32 v43, 0xffff0000, v245
    v_lshlrev_b32 v44, 16, v246
    v_and_b32 v45, 0xffff0000, v246
    v_lshlrev_b32 v46, 16, v247
    v_and_b32 v47, 0xffff0000, v247
    s_add_u32 m0, s57, 4096
    s_nop 0
    buffer_load_dwordx4 v10, s[20:23], s55 offen offset:0 lds
    v_add_f32 v48, v16, v20
    v_add_f32 v49, v17, v21
    v_add_f32 v50, v18, v22
    v_add_f32 v51, v19, v23
    v_add_f32 v48, v48, v24
    s_add_u32 m0, s57, 8128
    s_nop 0
    buffer_load_dwordx4 v10, s[20:23], s55 offen offset:64 lds
    v_add_f32 v49, v49, v25
    v_add_f32 v50, v50, v26
    v_add_f32 v51, v51, v27
    v_add_f32 v48, v48, v28
    v_add_f32 v49, v49, v29
    v_add_f32 v50, v50, v30
    s_add_u32 m0, s57, 12160
    s_nop 0
    buffer_load_dwordx4 v10, s[20:23], s55 offen offset:128 lds
    v_add_f32 v51, v51, v31
    v_add_f32 v48, v48, v32
    v_add_f32 v49, v49, v33
    v_add_f32 v50, v50, v34
    v_add_f32 v51, v51, v35
    s_add_u32 m0, s57, 32576
    s_nop 0
    buffer_load_dwordx4 v10, s[20:23], s55 offen offset:192 lds
    v_add_f32 v48, v48, v36
    v_add_f32 v49, v49, v37
    v_add_f32 v50, v50, v38
    v_add_f32 v51, v51, v39
    v_add_f32 v48, v48, v40
    v_add_f32 v49, v49, v41
    s_add_u32 m0, s57, 20224
    s_nop 0
    buffer_load_dwordx4 v10, s[20:23], s55 offen offset:256 lds
    v_add_f32 v50, v50, v42
    v_add_f32 v51, v51, v43
    v_add_f32 v48, v48, v44
    v_add_f32 v49, v49, v45
    v_add_f32 v50, v50, v46
    s_add_u32 m0, s57, 24256
    s_nop 0
    buffer_load_dwordx4 v10, s[20:23], s55 offen offset:320 lds
    v_add_f32 v51, v51, v47
    v_add_f32 v48, v48, v49
    v_add_f32 v50, v50, v51
    v_add_f32 v56, v48, v50
    s_nop 1
    v_add_f32_dpp v56, v56, v56 row_ror:8 row_mask:0xf bank_mask:0xf
    s_nop 1
    v_add_f32_dpp v56, v56, v56 row_ror:4 row_mask:0xf bank_mask:0xf
    s_add_u32 m0, s57, 28288
    s_nop 0
    buffer_load_dwordx4 v10, s[20:23], s55 offen offset:384 lds
    v_add_f32_dpp v56, v56, v56 row_ror:2 row_mask:0xf bank_mask:0xf
    s_nop 1
    v_add_f32_dpp v56, v56, v56 row_ror:1 row_mask:0xf bank_mask:0xf
    v_mov_b32 v49, v56
    s_nop 1
    v_permlane16_swap_b32 v56, v49
    v_add_f32 v56, v56, v49
    v_mul_f32 v56, 0x3a800000, v56
    s_cmp_eq_u32 s43, 2
    s_cbranch_scc0 LA_cn2
    s_mov_b32 s58, 106496
    s_call_b64 s[62:63], LA_cs
LA_cn2:
    s_waitcnt vmcnt(14)
    s_waitcnt lgkmcnt(0)
    s_barrier
    s_waitcnt vmcnt(13)
    ds_read_b64_tr_b16 v[100:101], v12
    ds_read_b64_tr_b16 v[102:103], v12 offset:128
    s_waitcnt lgkmcnt(0)
    s_mov_b32 m0, s59
    s_add_u32 s47, s60, 1024
    buffer_load_dwordx4 v11, s[32:35], s47 offen lds
    s_add_u32 s69, 5, s68
    s_and_b32 s69, s69, 3
    s_cselect_b32 s69, 0, 4
    s_add_u32 s69, s69, 5
    s_add_u32 s69, s69, s46
    s_and_b32 s69, s69, 15
    s_lshl_b32 s53, s69, 7
    s_lshl_b32 s54, s69, 17
    s_mul_i32 s55, s69, 458752
    s_add_u32 s56, s51, 106496
    s_add_u32 s57, s52, 106496
    s_add_u32 m0, s56, 0
    s_nop 0
    buffer_load_dwordx4 v6, s[12:15], s53 offen lds
    s_add_u32 s47, s61, 32768
    buffer_load_dwordx4 v[64:67], v211, s[12:15], s47 offen offset:256
    s_add_u32 s47, s61, 34816
    buffer_load_dwordx4 v[68:71], v211, s[12:15], s47 offen offset:256
    s_add_u32 s47, s61, 36864
    buffer_load_dwordx4 v[72:75], v211, s[12:15], s47 offen offset:256
    s_add_u32 s47, s61, 38912
    buffer_load_dwordx4 v[76:79], v211, s[12:15], s47 offen offset:256
    v_sub_f32 v16, v16, v56
    v_sub_f32 v17, v17, v56
    s_add_u32 m0, s56, 1024
    s_nop 0
    buffer_load_dwordx4 v7, s[12:15], s53 offen lds
    v_sub_f32 v18, v18, v56
    v_sub_f32 v19, v19, v56
    v_sub_f32 v20, v20, v56
    v_sub_f32 v21, v21, v56
    v_sub_f32 v22, v22, v56
    v_sub_f32 v23, v23, v56
    s_add_u32 m0, s56, 2048
    s_nop 0
    buffer_load_dwordx4 v14, s[12:15], s53 offen lds
    v_sub_f32 v24, v24, v56
    v_sub_f32 v25, v25, v56
    v_sub_f32 v26, v26, v56
    v_sub_f32 v27, v27, v56
    v_sub_f32 v28, v28, v56
    v_sub_f32 v29, v29, v56
    s_add_u32 m0, s56, 3072
    s_nop 0
    buffer_load_dwordx4 v15, s[12:15], s53 offen lds
    v_sub_f32 v30, v30, v56
    v_sub_f32 v31, v31, v56
    v_sub_f32 v32, v32, v56
    v_sub_f32 v33, v33, v56
    v_sub_f32 v34, v34, v56
    v_sub_f32 v35, v35, v56
    s_add_u32 m0, s57, 0
    s_nop 0
    buffer_load_dwordx4 v9, s[16:19], s54 offen offset:0 lds
    v_sub_f32 v36, v36, v56
    v_sub_f32 v37, v37, v56
    v_sub_f32 v38, v38, v56
    v_sub_f32 v39, v39, v56
    v_sub_f32 v40, v40, v56
    v_sub_f32 v41, v41, v56
    s_add_u32 m0, s57, 16320
    s_nop 0
    buffer_load_dwordx4 v9, s[16:19], s54 offen offset:64 lds
    v_sub_f32 v42, v42, v56
    v_sub_f32 v43, v43, v56
    v_sub_f32 v44, v44, v56
    v_sub_f32 v45, v45, v56
    v_sub_f32 v46, v46, v56
    v_sub_f32 v47, v47, v56
    s_add_u32 m0, s57, 4096
    s_nop 0
    buffer_load_dwordx4 v10, s[20:23], s55 offen offset:0 lds
    v_mul_f32 v48, v16, v16
    v_mul_f32 v49, v17, v17
    v_mul_f32 v50, v18, v18
    v_mul_f32 v51, v19, v19
    v_fmac_f32 v48, v20, v20
    v_fmac_f32 v49, v21, v21
    s_add_u32 m0, s57, 8128
    s_nop 0
    buffer_load_dwordx4 v10, s[20:23], s55 offen offset:64 lds
    v_fmac_f32 v50, v22, v22
    v_fmac_f32 v51, v23, v23
    v_fmac_f32 v48, v24, v24
    v_fmac_f32 v49, v25, v25
    v_fmac_f32 v50, v26, v26
    v_fmac_f32 v51, v27, v27
    s_add_u32 m0, s57, 12160
    s_nop 0
    buffer_load_dwordx4 v10, s[20:23], s55 offen offset:128 lds
    v_fmac_f32 v48, v28, v28
    v_fmac_f32 v49, v29, v29
    v_fmac_f32 v50, v30, v30
    v_fmac_f32 v51, v31, v31
    v_fmac_f32 v48, v32, v32
    v_fmac_f32 v49, v33, v33
    s_add_u32 m0, s57, 32576
    s_nop 0
    buffer_load_dwordx4 v10, s[20:23], s55 offen offset:192 lds
    v_fmac_f32 v50, v34, v34
    v_fmac_f32 v51, v35, v35
    v_fmac_f32 v48, v36, v36
    v_fmac_f32 v49, v37, v37
    v_fmac_f32 v50, v38, v38
    v_fmac_f32 v51, v39, v39
    s_add_u32 m0, s57, 20224
    s_nop 0
    buffer_load_dwordx4 v10, s[20:23], s55 offen offset:256 lds
    v_fmac_f32 v48, v40, v40
    v_fmac_f32 v49, v41, v41
    v_fmac_f32 v50, v42, v42
    v_fmac_f32 v51, v43, v43
    v_fmac_f32 v48, v44, v44
    v_fmac_f32 v49, v45, v45
    s_add_u32 m0, s57, 24256
    s_nop 0
    buffer_load_dwordx4 v10, s[20:23], s55 offen offset:320 lds
    v_fmac_f32 v50, v46, v46
    v_fmac_f32 v51, v47, v47
    v_add_f32 v48, v48, v49
    v_add_f32 v50, v50, v51
    v_add_f32 v57, v48, v50
    s_nop 1
    v_add_f32_dpp v57, v57, v57 row_ror:8 row_mask:0xf bank_mask:0xf
    s_add_u32 m0, s57, 28288
    s_nop 0
    buffer_load_dwordx4 v10, s[20:23], s55 offen offset:384 lds
    v_add_f32_dpp v57, v57, v57 row_ror:4 row_mask:0xf bank_mask:0xf
    s_nop 1
    v_add_f32_dpp v57, v57, v57 row_ror:2 row_mask:0xf bank_mask:0xf
    s_nop 1
    v_add_f32_dpp v57, v57, v57 row_ror:1 row_mask:0xf bank_mask:0xf
    v_mov_b32 v49, v57
    s_nop 1
    v_permlane16_swap_b32 v57, v49
    v_add_f32 v57, v57, v49
    v_mul_f32 v57, 0x3a800000, v57
    s_cmp_eq_u32 s43, 3
    s_cbranch_scc0 LA_cn3
    s_mov_b32 s58, 0
    s_call_b64 s[62:63], LA_cs
LA_cn3:
    s_waitcnt vmcnt(18)
    s_waitcnt lgkmcnt(0)
    s_barrier
    s_waitcnt vmcnt(17)
    ds_read_b64_tr_b16 v[104:105], v12
    ds_read_b64_tr_b16 v[106:107], v12 offset:128
    s_waitcnt lgkmcnt(0)
    s_mov_b32 m0, s59
    s_add_u32 s47, s60, 1536
    buffer_load_dwordx4 v11, s[32:35], s47 offen lds
    buffer_load_dword v218, v216, s[28:31], 0 offen sc1
    s_add_u32 s69, 6, s68
    s_and_b32 s69, s69, 3
    s_cselect_b32 s69, 0, 4
    s_add_u32 s69, s69, 6
    s_add_u32 s69, s69, s46
    s_and_b32 s69, s69, 15
    s_lshl_b32 s53, s69, 7
    s_lshl_b32 s54, s69, 17
    s_mul_i32 s55, s69, 458752
    s_add_u32 s56, s51, 0
    s_add_u32 s57, s52, 0
    s_add_u32 m0, s56, 0
    s_nop 0
    buffer_load_dwordx4 v6, s[12:15], s53 offen lds
    v_add_f32 v58, 0x3727c5ac, v57
    s_add_u32 m0, s56, 1024
    s_nop 0
    buffer_load_dwordx4 v7, s[12:15], s53 offen lds
    v_rsq_f32 v58, v58
    s_add_u32 m0, s56, 2048
    s_nop 0
    buffer_load_dwordx4 v14, s[12:15], s53 offen lds
    v_mul_f32 v59, v58, v58
    v_mul_f32 v59, v59, v57
    s_add_u32 m0, s56, 3072
    s_nop 0
    buffer_load_dwordx4 v15, s[12:15], s53 offen lds
    v_add_f32 v59, 0x3727c5ac, v59
    s_add_u32 m0, s57, 0
    s_nop 0
    buffer_load_dwordx4 v9, s[16:19], s54 offen offset:0 lds
    v_rsq_f32 v59, v59
    v_mul_f32 v52, 0x3e8293ee, v58
    s_add_u32 m0, s57, 16320
    s_nop 0
    buffer_load_dwordx4 v9, s[16:19], s54 offen offset:64 lds
    v_mul_f32 v48, v58, v59
    s_add_u32 m0, s57, 4096
    s_nop 0
    buffer_load_dwordx4 v10, s[20:23], s55 offen offset:0 lds
    v_mul_f32 v48, 0x3eeff558, v48
    v_mov_b32 v49, v48
    s_add_u32 m0, s57, 8128
    s_nop 0
    buffer_load_dwordx4 v10, s[20:23], s55 offen offset:64 lds
    v_mul_f32_e64 v50, -v48, v56
    s_add_u32 m0, s57, 12160
    s_nop 0
    buffer_load_dwordx4 v10, s[20:23], s55 offen offset:128 lds
    v_mov_b32 v51, v50
    v_mul_f32_e64 v53, -v52, v56
    s_add_u32 m0, s57, 32576
    s_nop 0
    buffer_load_dwordx4 v10, s[20:23], s55 offen offset:192 lds
    s_mov_b32 exec_lo, 1
    s_mov_b32 exec_hi, 1
    buffer_store_dwordx4 v[48:51], v206, s[24:27], s50 offen sc1
    buffer_store_dwordx2 v[52:53], v206, s[24:27], s50 offen offset:16 sc1
    s_mov_b64 exec, -1
    s_add_u32 m0, s57, 20224
    s_nop 0
    buffer_load_dwordx4 v10, s[20:23], s55 offen offset:256 lds
    s_waitcnt vmcnt(25)
    s_mov_b32 vcc_lo, 0xaaaaaaaa
    s_mov_b32 vcc_hi, 0xaaaaaaaa
    v_cndmask_b32_dpp v84, v64, v68, vcc quad_perm:[1,0,3,2] row_mask:0xf bank_mask:0xf
    v_cndmask_b32_dpp v85, v65, v69, vcc quad_perm:[1,0,3,2] row_mask:0xf bank_mask:0xf
    v_cndmask_b32_dpp v86, v66, v70, vcc quad_perm:[1,0,3,2] row_mask:0xf bank_mask:0xf
    v_cndmask_b32_dpp v87, v67, v71, vcc quad_perm:[1,0,3,2] row_mask:0xf bank_mask:0xf
    v_cndmask_b32_dpp v92, v72, v76, vcc quad_perm:[1,0,3,2] row_mask:0xf bank_mask:0xf
    v_cndmask_b32_dpp v93, v73, v77, vcc quad_perm:[1,0,3,2] row_mask:0xf bank_mask:0xf
    v_cndmask_b32_dpp v94, v74, v78, vcc quad_perm:[1,0,3,2] row_mask:0xf bank_mask:0xf
    v_cndmask_b32_dpp v95, v75, v79, vcc quad_perm:[1,0,3,2] row_mask:0xf bank_mask:0xf
    s_add_u32 m0, s57, 24256
    s_nop 0
    buffer_load_dwordx4 v10, s[20:23], s55 offen offset:320 lds
    s_not_b64 vcc, vcc
    v_cndmask_b32_dpp v80, v68, v64, vcc quad_perm:[1,0,3,2] row_mask:0xf bank_mask:0xf
    v_cndmask_b32_dpp v81, v69, v65, vcc quad_perm:[1,0,3,2] row_mask:0xf bank_mask:0xf
    v_cndmask_b32_dpp v82, v70, v66, vcc quad_perm:[1,0,3,2] row_mask:0xf bank_mask:0xf
    v_cndmask_b32_dpp v83, v71, v67, vcc quad_perm:[1,0,3,2] row_mask:0xf bank_mask:0xf
    v_cndmask_b32_dpp v88, v76, v72, vcc quad_perm:[1,0,3,2] row_mask:0xf bank_mask:0xf
    v_cndmask_b32_dpp v89, v77, v73, vcc quad_perm:[1,0,3,2] row_mask:0xf bank_mask:0xf
    v_cndmask_b32_dpp v90, v78, v74, vcc quad_perm:[1,0,3,2] row_mask:0xf bank_mask:0xf
    v_cndmask_b32_dpp v91, v79, v75, vcc quad_perm:[1,0,3,2] row_mask:0xf bank_mask:0xf
    s_add_u32 m0, s57, 28288
    s_nop 0
    buffer_load_dwordx4 v10, s[20:23], s55 offen offset:384 lds
    s_mov_b32 vcc_lo, 0xcccccccc
    s_mov_b32 vcc_hi, 0xcccccccc
    v_cndmask_b32_dpp v72, v80, v88, vcc quad_perm:[2,3,0,1] row_mask:0xf bank_mask:0xf
    v_cndmask_b32_dpp v73, v81, v89, vcc quad_perm:[2,3,0,1] row_mask:0xf bank_mask:0xf
    v_cndmask_b32_dpp v74, v82, v90, vcc quad_perm:[2,3,0,1] row_mask:0xf bank_mask:0xf
    v_cndmask_b32_dpp v75, v83, v91, vcc quad_perm:[2,3,0,1] row_mask:0xf bank_mask:0xf
    v_cndmask_b32_dpp v76, v84, v92, vcc quad_perm:[2,3,0,1] row_mask:0xf bank_mask:0xf
    v_cndmask_b32_dpp v77, v85, v93, vcc quad_perm:[2,3,0,1] row_mask:0xf bank_mask:0xf
    v_cndmask_b32_dpp v78, v86, v94, vcc quad_perm:[2,3,0,1] row_mask:0xf bank_mask:0xf
    v_cndmask_b32_dpp v79, v87, v95, vcc quad_perm:[2,3,0,1] row_mask:0xf bank_mask:0xf
    s_not_b64 vcc, vcc
    v_cndmask_b32_dpp v64, v88, v80, vcc quad_perm:[2,3,0,1] row_mask:0xf bank_mask:0xf
    v_cndmask_b32_dpp v65, v89, v81, vcc quad_perm:[2,3,0,1] row_mask:0xf bank_mask:0xf
    v_cndmask_b32_dpp v66, v90, v82, vcc quad_perm:[2,3,0,1] row_mask:0xf bank_mask:0xf
    v_cndmask_b32_dpp v67, v91, v83, vcc quad_perm:[2,3,0,1] row_mask:0xf bank_mask:0xf
    v_cndmask_b32_dpp v68, v92, v84, vcc quad_perm:[2,3,0,1] row_mask:0xf bank_mask:0xf
    v_cndmask_b32_dpp v69, v93, v85, vcc quad_perm:[2,3,0,1] row_mask:0xf bank_mask:0xf
    v_cndmask_b32_dpp v70, v94, v86, vcc quad_perm:[2,3,0,1] row_mask:0xf bank_mask:0xf
    v_cndmask_b32_dpp v71, v95, v87, vcc quad_perm:[2,3,0,1] row_mask:0xf bank_mask:0xf
    s_cmp_eq_u32 s43, 4
    s_cbranch_scc0 LA_cn4
    s_mov_b32 s58, 53248
    s_call_b64 s[62:63], LA_cs
LA_cn4:
    s_waitcnt vmcnt(15)
    s_waitcnt lgkmcnt(0)
    s_barrier
    s_waitcnt vmcnt(13)
    v_cmp_ne_u32 vcc, 1, v218
    s_nop 4
    s_cbranch_vccnz LA_p1_s
LA_p1_r:
    s_waitcnt vmcnt(0)
    s_mov_b64 exec, 1
    buffer_store_dword v217, v219, s[24:27], s66 offen sc1
    s_mov_b64 exec, -1
    s_waitcnt vmcnt(14)
    ds_read_b64_tr_b16 v[108:109], v12
    ds_read_b64_tr_b16 v[110:111], v12 offset:128
    s_waitcnt lgkmcnt(0)
    s_mov_b32 m0, s59
    s_add_u32 s47, s60, 8192
    buffer_load_dwordx4 v11, s[32:35], s47 offen lds
    s_add_u32 s69, 7, s68
    s_and_b32 s69, s69, 3
    s_cselect_b32 s69, 0, 4
    s_add_u32 s69, s69, 7
    s_add_u32 s69, s69, s46
    s_and_b32 s69, s69, 15
    s_lshl_b32 s53, s69, 7
    s_lshl_b32 s54, s69, 17
    s_mul_i32 s55, s69, 458752
    s_add_u32 s56, s51, 53248
    s_add_u32 s57, s52, 53248
    s_add_u32 m0, s56, 0
    s_nop 0
    buffer_load_dwordx4 v6, s[12:15], s53 offen lds
    s_add_u32 m0, s56, 1024
    s_nop 0
    buffer_load_dwordx4 v7, s[12:15], s53 offen lds
    s_add_u32 m0, s56, 2048
    s_nop 0
    buffer_load_dwordx4 v14, s[12:15], s53 offen lds
    s_add_u32 m0, s56, 3072
    s_nop 0
    buffer_load_dwordx4 v15, s[12:15], s53 offen lds
    s_add_u32 s47, s61, 0
    buffer_load_dwordx4 v[16:19], v211, s[12:15], s47 offen offset:0
    s_add_u32 m0, s57, 0
    s_nop 0
    buffer_load_dwordx4 v9, s[16:19], s54 offen offset:0 lds
    s_add_u32 m0, s57, 16320
    s_nop 0
    buffer_load_dwordx4 v9, s[16:19], s54 offen offset:64 lds
    s_add_u32 m0, s57, 4096
    s_nop 0
    buffer_load_dwordx4 v10, s[20:23], s55 offen offset:0 lds
    s_add_u32 s47, s61, 2048
    buffer_load_dwordx4 v[20:23], v211, s[12:15], s47 offen offset:0
    s_add_u32 m0, s57, 8128
    s_nop 0
    buffer_load_dwordx4 v10, s[20:23], s55 offen offset:64 lds
    s_add_u32 m0, s57, 12160
    s_nop 0
    buffer_load_dwordx4 v10, s[20:23], s55 offen offset:128 lds
    s_add_u32 m0, s57, 32576
    s_nop 0
    buffer_load_dwordx4 v10, s[20:23], s55 offen offset:192 lds
    s_add_u32 s47, s61, 4096
    buffer_load_dwordx4 v[24:27], v211, s[12:15], s47 offen offset:0
    s_add_u32 m0, s57, 20224
    s_nop 0
    buffer_load_dwordx4 v10, s[20:23], s55 offen offset:256 lds
    s_add_u32 m0, s57, 24256
    s_nop 0
    buffer_load_dwordx4 v10, s[20:23], s55 offen offset:320 lds
    s_add_u32 m0, s57, 28288
    s_nop 0
    buffer_load_dwordx4 v10, s[20:23], s55 offen offset:384 lds
    s_add_u32 s47, s61, 6144
    buffer_load_dwordx4 v[28:31], v211, s[12:15], s47 offen offset:0
    s_cmp_eq_u32 s43, 5
    s_cbranch_scc0 LA_cn5
    s_mov_b32 s58, 106496
    s_call_b64 s[62:63], LA_cs
LA_cn5:
    s_waitcnt vmcnt(18)
    s_waitcnt lgkmcnt(0)
    s_barrier
    s_waitcnt vmcnt(17)
    ds_read_b64_tr_b16 v[112:113], v12
    ds_read_b64_tr_b16 v[114:115], v12 offset:128
    s_waitcnt lgkmcnt(0)
    s_mov_b32 m0, s59
    s_add_u32 s47, s60, 8704
    buffer_load_dwordx4 v11, s[32:35], s47 offen lds
    s_add_u32 s69, 8, s68
    s_and_b32 s69, s69, 3
    s_cselect_b32 s69, 0, 4
    s_add_u32 s69, s69, 8
    s_add_u32 s69, s69, s46
    s_and_b32 s69, s69, 15
    s_lshl_b32 s53, s69, 7
    s_lshl_b32 s54, s69, 17
    s_mul_i32 s55, s69, 458752
    s_add_u32 s56, s51, 106496
    s_add_u32 s57, s52, 106496
    s_add_u32 m0, s56, 0
    s_nop 0
    buffer_load_dwordx4 v6, s[12:15], s53 offen lds
    s_add_u32 m0, s56, 1024
    s_nop 0
    buffer_load_dwordx4 v7, s[12:15], s53 offen lds
    s_add_u32 s47, s61, 32768
    buffer_load_dwordx4 v[32:35], v211, s[12:15], s47 offen offset:0
    s_add_u32 m0, s56, 2048
    s_nop 0
    buffer_load_dwordx4 v14, s[12:15], s53 offen lds
    s_add_u32 s47, s61, 34816
    buffer_load_dwordx4 v[36:39], v211, s[12:15], s47 offen offset:0
    s_add_u32 m0, s56, 3072
    s_nop 0
    buffer_load_dwordx4 v15, s[12:15], s53 offen lds
    s_add_u32 m0, s57, 0
    s_nop 0
    buffer_load_dwordx4 v9, s[16:19], s54 offen offset:0 lds
    s_add_u32 s47, s61, 36864
    buffer_load_dwordx4 v[40:43], v211, s[12:15], s47 offen offset:0
    s_add_u32 m0, s57, 16320
    s_nop 0
    buffer_load_dwordx4 v9, s[16:19], s54 offen offset:64 lds
    s_add_u32 s47, s61, 38912
    buffer_load_dwordx4 v[44:47], v211, s[12:15], s47 offen offset:0
    s_add_u32 m0, s57, 4096
    s_nop 0
    buffer_load_dwordx4 v10, s[20:23], s55 offen offset:0 lds
    s_add_u32 m0, s57, 8128
    s_nop 0
    buffer_load_dwordx4 v10, s[20:23], s55 offen offset:64 lds
    s_waitcnt vmcnt(13)
    s_add_u32 m0, s57, 12160
    s_nop 0
    buffer_load_dwordx4 v10, s[20:23], s55 offen offset:128 lds
    s_mov_b32 vcc_lo, 0xaaaaaaaa
    s_mov_b32 vcc_hi, 0xaaaaaaaa
    v_cndmask_b32_dpp v84, v16, v20, vcc quad_perm:[1,0,3,2] row_mask:0xf bank_mask:0xf
    v_cndmask_b32_dpp v85, v17, v21, vcc quad_perm:[1,0,3,2] row_mask:0xf bank_mask:0xf
    v_cndmask_b32_dpp v86, v18, v22, vcc quad_perm:[1,0,3,2] row_mask:0xf bank_mask:0xf
    v_cndmask_b32_dpp v87, v19, v23, vcc quad_perm:[1,0,3,2] row_mask:0xf bank_mask:0xf
    v_cndmask_b32_dpp v92, v24, v28, vcc quad_perm:[1,0,3,2] row_mask:0xf bank_mask:0xf
    v_cndmask_b32_dpp v93, v25, v29, vcc quad_perm:[1,0,3,2] row_mask:0xf bank_mask:0xf
    v_cndmask_b32_dpp v94, v26, v30, vcc quad_perm:[1,0,3,2] row_mask:0xf bank_mask:0xf
    v_cndmask_b32_dpp v95, v27, v31, vcc quad_perm:[1,0,3,2] row_mask:0xf bank_mask:0xf
    s_add_u32 m0, s57, 32576
    s_nop 0
    buffer_load_dwordx4 v10, s[20:23], s55 offen offset:192 lds
    s_add_u32 m0, s57, 20224
    s_nop 0
    buffer_load_dwordx4 v10, s[20:23], s55 offen offset:256 lds
    s_not_b64 vcc, vcc
    v_cndmask_b32_dpp v80, v20, v16, vcc quad_perm:[1,0,3,2] row_mask:0xf bank_mask:0xf
    v_cndmask_b32_dpp v81, v21, v17, vcc quad_perm:[1,0,3,2] row_mask:0xf bank_mask:0xf
    v_cndmask_b32_dpp v82, v22, v18, vcc quad_perm:[1,0,3,2] row_mask:0xf bank_mask:0xf
    v_cndmask_b32_dpp v83, v23, v19, vcc quad_perm:[1,0,3,2] row_mask:0xf bank_mask:0xf
    v_cndmask_b32_dpp v88, v28, v24, vcc quad_perm:[1,0,3,2] row_mask:0xf bank_mask:0xf
    v_cndmask_b32_dpp v89, v29, v25, vcc quad_perm:[1,0,3,2] row_mask:0xf bank_mask:0xf
    v_cndmask_b32_dpp v90, v30, v26, vcc quad_perm:[1,0,3,2] row_mask:0xf bank_mask:0xf
    v_cndmask_b32_dpp v91, v31, v27, vcc quad_perm:[1,0,3,2] row_mask:0xf bank_mask:0xf
    s_add_u32 m0, s57, 24256
    s_nop 0
    buffer_load_dwordx4 v10, s[20:23], s55 offen offset:320 lds
    s_mov_b32 vcc_lo, 0xcccccccc
    s_mov_b32 vcc_hi, 0xcccccccc
    v_cndmask_b32_dpp v24, v80, v88, vcc quad_perm:[2,3,0,1] row_mask:0xf bank_mask:0xf
    v_cndmask_b32_dpp v25, v81, v89, vcc quad_perm:[2,3,0,1] row_mask:0xf bank_mask:0xf
    v_cndmask_b32_dpp v26, v82, v90, vcc quad_perm:[2,3,0,1] row_mask:0xf bank_mask:0xf
    v_cndmask_b32_dpp v27, v83, v91, vcc quad_perm:[2,3,0,1] row_mask:0xf bank_mask:0xf
    v_cndmask_b32_dpp v28, v84, v92, vcc quad_perm:[2,3,0,1] row_mask:0xf bank_mask:0xf
    v_cndmask_b32_dpp v29, v85, v93, vcc quad_perm:[2,3,0,1] row_mask:0xf bank_mask:0xf
    v_cndmask_b32_dpp v30, v86, v94, vcc quad_perm:[2,3,0,1] row_mask:0xf bank_mask:0xf
    v_cndmask_b32_dpp v31, v87, v95, vcc quad_perm:[2,3,0,1] row_mask:0xf bank_mask:0xf
    s_add_u32 m0, s57, 28288
    s_nop 0
    buffer_load_dwordx4 v10, s[20:23], s55 offen offset:384 lds
    s_not_b64 vcc, vcc
    v_cndmask_b32_dpp v16, v88, v80, vcc quad_perm:[2,3,0,1] row_mask:0xf bank_mask:0xf
    v_cndmask_b32_dpp v17, v89, v81, vcc quad_perm:[2,3,0,1] row_mask:0xf bank_mask:0xf
    v_cndmask_b32_dpp v18, v90, v82, vcc quad_perm:[2,3,0,1] row_mask:0xf bank_mask:0xf
    v_cndmask_b32_dpp v19, v91, v83, vcc quad_perm:[2,3,0,1] row_mask:0xf bank_mask:0xf
    v_cndmask_b32_dpp v20, v92, v84, vcc quad_perm:[2,3,0,1] row_mask:0xf bank_mask:0xf
    v_cndmask_b32_dpp v21, v93, v85, vcc quad_perm:[2,3,0,1] row_mask:0xf bank_mask:0xf
    v_cndmask_b32_dpp v22, v94, v86, vcc quad_perm:[2,3,0,1] row_mask:0xf bank_mask:0xf
    v_cndmask_b32_dpp v23, v95, v87, vcc quad_perm:[2,3,0,1] row_mask:0xf bank_mask:0xf
    s_cmp_eq_u32 s43, 6
    s_cbranch_scc0 LA_cn6
    s_mov_b32 s58, 0
    s_call_b64 s[62:63], LA_cs
LA_cn6:
    s_waitcnt vmcnt(19)
    s_waitcnt lgkmcnt(0)
    s_barrier
    s_waitcnt vmcnt(17)
    ds_read_b64_tr_b16 v[116:117], v12
    ds_read_b64_tr_b16 v[118:119], v12 offset:128
    s_waitcnt lgkmcnt(0)
    s_mov_b32 m0, s59
    s_add_u32 s47, s60, 9216
    buffer_load_dwordx4 v11, s[32:35], s47 offen lds
    s_add_u32 s69, 9, s68
    s_and_b32 s69, s69, 3
    s_cselect_b32 s69, 0, 4
    s_add_u32 s69, s69, 9
    s_add_u32 s69, s69, s46
    s_and_b32 s69, s69, 15
    s_lshl_b32 s53, s69, 7
    s_lshl_b32 s54, s69, 17
    s_mul_i32 s55, s69, 458752
    s_add_u32 s56, s51, 0
    s_add_u32 s57, s52, 0
    s_add_u32 m0, s56, 0
    s_nop 0
    buffer_load_dwordx4 v6, s[12:15], s53 offen lds
    s_add_u32 m0, s56, 1024
    s_nop 0
    buffer_load_dwordx4 v7, s[12:15], s53 offen lds
    s_add_u32 s47, s61, 0
    buffer_load_dwordx4 v[48:51], v211, s[12:15], s47 offen offset:256
    s_add_u32 m0, s56, 2048
    s_nop 0
    buffer_load_dwordx4 v14, s[12:15], s53 offen lds
    s_add_u32 s47, s61, 2048
    buffer_load_dwordx4 v[52:55], v211, s[12:15], s47 offen offset:256
    s_add_u32 m0, s56, 3072
    s_nop 0
    buffer_load_dwordx4 v15, s[12:15], s53 offen lds
    s_add_u32 m0, s57, 0
    s_nop 0
    buffer_load_dwordx4 v9, s[16:19], s54 offen offset:0 lds
    s_add_u32 s47, s61, 4096
    buffer_load_dwordx4 v[56:59], v211, s[12:15], s47 offen offset:256
    s_add_u32 m0, s57, 16320
    s_nop 0
    buffer_load_dwordx4 v9, s[16:19], s54 offen offset:64 lds
    s_add_u32 s47, s61, 6144
    buffer_load_dwordx4 v[60:63], v211, s[12:15], s47 offen offset:256
    s_add_u32 m0, s57, 4096
    s_nop 0
    buffer_load_dwordx4 v10, s[20:23], s55 offen offset:0 lds
    s_add_u32 m0, s57, 8128
    s_nop 0
    buffer_load_dwordx4 v10, s[20:23], s55 offen offset:64 lds
    s_waitcnt vmcnt(20)
    s_add_u32 m0, s57, 12160
    s_nop 0
    buffer_load_dwordx4 v10, s[20:23], s55 offen offset:128 lds
    s_mov_b32 vcc_lo, 0xaaaaaaaa
    s_mov_b32 vcc_hi, 0xaaaaaaaa
    v_cndmask_b32_dpp v84, v32, v36, vcc quad_perm:[1,0,3,2] row_mask:0xf bank_mask:0xf
    v_cndmask_b32_dpp v85, v33, v37, vcc quad_perm:[1,0,3,2] row_mask:0xf bank_mask:0xf
    v_cndmask_b32_dpp v86, v34, v38, vcc quad_perm:[1,0,3,2] row_mask:0xf bank_mask:0xf
    v_cndmask_b32_dpp v87, v35, v39, vcc quad_perm:[1,0,3,2] row_mask:0xf bank_mask:0xf
    v_cndmask_b32_dpp v92, v40, v44, vcc quad_perm:[1,0,3,2] row_mask:0xf bank_mask:0xf
    v_cndmask_b32_dpp v93, v41, v45, vcc quad_perm:[1,0,3,2] row_mask:0xf bank_mask:0xf
    v_cndmask_b32_dpp v94, v42, v46, vcc quad_perm:[1,0,3,2] row_mask:0xf bank_mask:0xf
    v_cndmask_b32_dpp v95, v43, v47, vcc quad_perm:[1,0,3,2] row_mask:0xf bank_mask:0xf
    s_add_u32 m0, s57, 32576
    s_nop 0
    buffer_load_dwordx4 v10, s[20:23], s55 offen offset:192 lds
    s_add_u32 m0, s57, 20224
    s_nop 0
    buffer_load_dwordx4 v10, s[20:23], s55 offen offset:256 lds
    s_not_b64 vcc, vcc
    v_cndmask_b32_dpp v80, v36, v32, vcc quad_perm:[1,0,3,2] row_mask:0xf bank_mask:0xf
    v_cndmask_b32_dpp v81, v37, v33, vcc quad_perm:[1,0,3,2] row_mask:0xf bank_mask:0xf
    v_cndmask_b32_dpp v82, v38, v34, vcc quad_perm:[1,0,3,2] row_mask:0xf bank_mask:0xf
    v_cndmask_b32_dpp v83, v39, v35, vcc quad_perm:[1,0,3,2] row_mask:0xf bank_mask:0xf
    v_cndmask_b32_dpp v88, v44, v40, vcc quad_perm:[1,0,3,2] row_mask:0xf bank_mask:0xf
    v_cndmask_b32_dpp v89, v45, v41, vcc quad_perm:[1,0,3,2] row_mask:0xf bank_mask:0xf
    v_cndmask_b32_dpp v90, v46, v42, vcc quad_perm:[1,0,3,2] row_mask:0xf bank_mask:0xf
    v_cndmask_b32_dpp v91, v47, v43, vcc quad_perm:[1,0,3,2] row_mask:0xf bank_mask:0xf
    s_add_u32 m0, s57, 24256
    s_nop 0
    buffer_load_dwordx4 v10, s[20:23], s55 offen offset:320 lds
    s_mov_b32 vcc_lo, 0xcccccccc
    s_mov_b32 vcc_hi, 0xcccccccc
    v_cndmask_b32_dpp v40, v80, v88, vcc quad_perm:[2,3,0,1] row_mask:0xf bank_mask:0xf
    v_cndmask_b32_dpp v41, v81, v89, vcc quad_perm:[2,3,0,1] row_mask:0xf bank_mask:0xf
    v_cndmask_b32_dpp v42, v82, v90, vcc quad_perm:[2,3,0,1] row_mask:0xf bank_mask:0xf
    v_cndmask_b32_dpp v43, v83, v91, vcc quad_perm:[2,3,0,1] row_mask:0xf bank_mask:0xf
    v_cndmask_b32_dpp v44, v84, v92, vcc quad_perm:[2,3,0,1] row_mask:0xf bank_mask:0xf
    v_cndmask_b32_dpp v45, v85, v93, vcc quad_perm:[2,3,0,1] row_mask:0xf bank_mask:0xf
    v_cndmask_b32_dpp v46, v86, v94, vcc quad_perm:[2,3,0,1] row_mask:0xf bank_mask:0xf
    v_cndmask_b32_dpp v47, v87, v95, vcc quad_perm:[2,3,0,1] row_mask:0xf bank_mask:0xf
    s_add_u32 m0, s57, 28288
    s_nop 0
    buffer_load_dwordx4 v10, s[20:23], s55 offen offset:384 lds
    s_not_b64 vcc, vcc
    v_cndmask_b32_dpp v32, v88, v80, vcc quad_perm:[2,3,0,1] row_mask:0xf bank_mask:0xf
    v_cndmask_b32_dpp v33, v89, v81, vcc quad_perm:[2,3,0,1] row_mask:0xf bank_mask:0xf
    v_cndmask_b32_dpp v34, v90, v82, vcc quad_perm:[2,3,0,1] row_mask:0xf bank_mask:0xf
    v_cndmask_b32_dpp v35, v91, v83, vcc quad_perm:[2,3,0,1] row_mask:0xf bank_mask:0xf
    v_cndmask_b32_dpp v36, v92, v84, vcc quad_perm:[2,3,0,1] row_mask:0xf bank_mask:0xf
    v_cndmask_b32_dpp v37, v93, v85, vcc quad_perm:[2,3,0,1] row_mask:0xf bank_mask:0xf
    v_cndmask_b32_dpp v38, v94, v86, vcc quad_perm:[2,3,0,1] row_mask:0xf bank_mask:0xf
    v_cndmask_b32_dpp v39, v95, v87, vcc quad_perm:[2,3,0,1] row_mask:0xf bank_mask:0xf
    s_cmp_eq_u32 s43, 7
    s_cbranch_scc0 LA_cn7
    s_mov_b32 s58, 53248
    s_call_b64 s[62:63], LA_cs
LA_cn7:
    s_waitcnt vmcnt(18)
    s_waitcnt lgkmcnt(0)
    s_barrier
    s_waitcnt vmcnt(0)
    s_mov_b64 exec, 1
    buffer_store_dword v217, v219, s[24:27], s67 offen sc1
    s_mov_b64 exec, -1
    s_waitcnt vmcnt(17)
    ds_read_b64_tr_b16 v[120:121], v12
    ds_read_b64_tr_b16 v[122:123], v12 offset:128
    s_waitcnt lgkmcnt(0)
    s_mov_b32 m0, s59
    s_add_u32 s47, s60, 9728
    buffer_load_dwordx4 v11, s[32:35], s47 offen lds
    buffer_load_dword v218, v224, s[24:27], s64 offen sc1
    s_add_u32 s69, 10, s68
    s_and_b32 s69, s69, 3
    s_cselect_b32 s69, 0, 4
    s_add_u32 s69, s69, 10
    s_add_u32 s69, s69, s46
    s_and_b32 s69, s69, 15
    s_lshl_b32 s53, s69, 7
    s_lshl_b32 s54, s69, 17
    s_mul_i32 s55, s69, 458752
    s_add_u32 s56, s51, 53248
    s_add_u32 s57, s52, 53248
    s_add_u32 m0, s56, 0
    s_nop 0
    buffer_load_dwordx4 v6, s[12:15], s53 offen lds
    s_add_u32 m0, s56, 1024
    s_nop 0
    buffer_load_dwordx4 v7, s[12:15], s53 offen lds
    s_add_u32 m0, s56, 2048
    s_nop 0
    buffer_load_dwordx4 v14, s[12:15], s53 offen lds
    s_waitcnt vmcnt(12)
    s_add_u32 m0, s56, 3072
    s_nop 0
    buffer_load_dwordx4 v15, s[12:15], s53 offen lds
    s_add_u32 m0, s57, 0
    s_nop 0
    buffer_load_dwordx4 v9, s[16:19], s54 offen offset:0 lds
    s_add_u32 m0, s57, 16320
    s_nop 0
    buffer_load_dwordx4 v9, s[16:19], s54 offen offset:64 lds
    s_mov_b32 vcc_lo, 0xaaaaaaaa
    s_mov_b32 vcc_hi, 0xaaaaaaaa
    v_cndmask_b32_dpp v84, v48, v52, vcc quad_perm:[1,0,3,2] row_mask:0xf bank_mask:0xf
    v_cndmask_b32_dpp v85, v49, v53, vcc quad_perm:[1,0,3,2] row_mask:0xf bank_mask:0xf
    v_cndmask_b32_dpp v86, v50, v54, vcc quad_perm:[1,0,3,2] row_mask:0xf bank_mask:0xf
    v_cndmask_b32_dpp v87, v51, v55, vcc quad_perm:[1,0,3,2] row_mask:0xf bank_mask:0xf
    v_cndmask_b32_dpp v92, v56, v60, vcc quad_perm:[1,0,3,2] row_mask:0xf bank_mask:0xf
    v_cndmask_b32_dpp v93, v57, v61, vcc quad_perm:[1,0,3,2] row_mask:0xf bank_mask:0xf
    v_cndmask_b32_dpp v94, v58, v62, vcc quad_perm:[1,0,3,2] row_mask:0xf bank_mask:0xf
    v_cndmask_b32_dpp v95, v59, v63, vcc quad_perm:[1,0,3,2] row_mask:0xf bank_mask:0xf
    s_add_u32 m0, s57, 4096
    s_nop 0
    buffer_load_dwordx4 v10, s[20:23], s55 offen offset:0 lds
    s_add_u32 m0, s57, 8128
    s_nop 0
    buffer_load_dwordx4 v10, s[20:23], s55 offen offset:64 lds
    s_not_b64 vcc, vcc
    v_cndmask_b32_dpp v80, v52, v48, vcc quad_perm:[1,0,3,2] row_mask:0xf bank_mask:0xf
    v_cndmask_b32_dpp v81, v53, v49, vcc quad_perm:[1,0,3,2] row_mask:0xf bank_mask:0xf
    v_cndmask_b32_dpp v82, v54, v50, vcc quad_perm:[1,0,3,2] row_mask:0xf bank_mask:0xf
    v_cndmask_b32_dpp v83, v55, v51, vcc quad_perm:[1,0,3,2] row_mask:0xf bank_mask:0xf
    v_cndmask_b32_dpp v88, v60, v56, vcc quad_perm:[1,0,3,2] row_mask:0xf bank_mask:0xf
    v_cndmask_b32_dpp v89, v61, v57, vcc quad_perm:[1,0,3,2] row_mask:0xf bank_mask:0xf
    v_cndmask_b32_dpp v90, v62, v58, vcc quad_perm:[1,0,3,2] row_mask:0xf bank_mask:0xf
    v_cndmask_b32_dpp v91, v63, v59, vcc quad_perm:[1,0,3,2] row_mask:0xf bank_mask:0xf
    s_add_u32 m0, s57, 12160
    s_nop 0
    buffer_load_dwordx4 v10, s[20:23], s55 offen offset:128 lds
    s_add_u32 m0, s57, 32576
    s_nop 0
    buffer_load_dwordx4 v10, s[20:23], s55 offen offset:192 lds
    s_add_u32 m0, s57, 20224
    s_nop 0
    buffer_load_dwordx4 v10, s[20:23], s55 offen offset:256 lds
    s_mov_b32 vcc_lo, 0xcccccccc
    s_mov_b32 vcc_hi, 0xcccccccc
    v_cndmask_b32_dpp v56, v80, v88, vcc quad_perm:[2,3,0,1] row_mask:0xf bank_mask:0xf
    v_cndmask_b32_dpp v57, v81, v89, vcc quad_perm:[2,3,0,1] row_mask:0xf bank_mask:0xf
    v_cndmask_b32_dpp v58, v82, v90, vcc quad_perm:[2,3,0,1] row_mask:0xf bank_mask:0xf
    v_cndmask_b32_dpp v59, v83, v91, vcc quad_perm:[2,3,0,1] row_mask:0xf bank_mask:0xf
    v_cndmask_b32_dpp v60, v84, v92, vcc quad_perm:[2,3,0,1] row_mask:0xf bank_mask:0xf
    v_cndmask_b32_dpp v61, v85, v93, vcc quad_perm:[2,3,0,1] row_mask:0xf bank_mask:0xf
    v_cndmask_b32_dpp v62, v86, v94, vcc quad_perm:[2,3,0,1] row_mask:0xf bank_mask:0xf
    v_cndmask_b32_dpp v63, v87, v95, vcc quad_perm:[2,3,0,1] row_mask:0xf bank_mask:0xf
    s_add_u32 m0, s57, 24256
    s_nop 0
    buffer_load_dwordx4 v10, s[20:23], s55 offen offset:320 lds
    s_add_u32 m0, s57, 28288
    s_nop 0
    buffer_load_dwordx4 v10, s[20:23], s55 offen offset:384 lds
    s_not_b64 vcc, vcc
    v_cndmask_b32_dpp v48, v88, v80, vcc quad_perm:[2,3,0,1] row_mask:0xf bank_mask:0xf
    v_cndmask_b32_dpp v49, v89, v81, vcc quad_perm:[2,3,0,1] row_mask:0xf bank_mask:0xf
    v_cndmask_b32_dpp v50, v90, v82, vcc quad_perm:[2,3,0,1] row_mask:0xf bank_mask:0xf
    v_cndmask_b32_dpp v51, v91, v83, vcc quad_perm:[2,3,0,1] row_mask:0xf bank_mask:0xf
    v_cndmask_b32_dpp v52, v92, v84, vcc quad_perm:[2,3,0,1] row_mask:0xf bank_mask:0xf
    v_cndmask_b32_dpp v53, v93, v85, vcc quad_perm:[2,3,0,1] row_mask:0xf bank_mask:0xf
    v_cndmask_b32_dpp v54, v94, v86, vcc quad_perm:[2,3,0,1] row_mask:0xf bank_mask:0xf
    v_cndmask_b32_dpp v55, v95, v87, vcc quad_perm:[2,3,0,1] row_mask:0xf bank_mask:0xf
    s_waitcnt vmcnt(15)
    s_waitcnt lgkmcnt(0)
    s_barrier
    s_waitcnt vmcnt(14)
    ds_read_b64_tr_b16 v[124:125], v12
    ds_read_b64_tr_b16 v[126:127], v12 offset:128
    s_waitcnt lgkmcnt(0)
    s_waitcnt vmcnt(13)
    v_cmp_ne_u32 vcc, 1, v218
    s_nop 4
    s_cbranch_vccnz LA_p2_s
LA_p2_r:
    v_lshlrev_b32 v214, 5, v3
    s_lshl_b32 s47, s45, 10
    s_add_u32 s47, s47, 0x400000
    buffer_load_dwordx2 v[232:233], v214, s[24:27], s47 offen offset:16 sc1
    buffer_load_dwordx2 v[234:235], v214, s[24:27], s47 offen offset:528 sc1
    s_add_u32 s69, 11, s68
    s_and_b32 s69, s69, 3
    s_cselect_b32 s69, 0, 4
    s_add_u32 s69, s69, 11
    s_add_u32 s69, s69, s46
    s_and_b32 s69, s69, 15
    s_lshl_b32 s53, s69, 7
    s_lshl_b32 s54, s69, 17
    s_mul_i32 s55, s69, 458752
    s_add_u32 s56, s51, 106496
    s_add_u32 s57, s52, 106496
    s_add_u32 m0, s56, 0
    s_nop 0
    buffer_load_dwordx4 v6, s[12:15], s53 offen lds
    s_add_u32 m0, s56, 1024
    s_nop 0
    buffer_load_dwordx4 v7, s[12:15], s53 offen lds
    v_mfma_f32_16x16x32_bf16 v[80:83], v[96:99], v[16:19], 0
    v_mfma_f32_16x16x32_bf16 v[84:87], v[96:99], v[32:35], 0
    v_mfma_f32_16x16x32_bf16 v[88:91], v[96:99], v[188:191], 0
    s_add_u32 m0, s56, 2048
    s_nop 0
    buffer_load_dwordx4 v14, s[12:15], s53 offen lds
    s_add_u32 m0, s56, 3072
    s_nop 0
    buffer_load_dwordx4 v15, s[12:15], s53 offen lds
    v_mfma_f32_16x16x32_bf16 v[80:83], v[100:103], v[20:23], v[80:83]
    v_mfma_f32_16x16x32_bf16 v[84:87], v[100:103], v[36:39], v[84:87]
    v_mfma_f32_16x16x32_bf16 v[88:91], v[100:103], v[188:191], v[88:91]
    s_add_u32 m0, s57, 0
    s_nop 0
    buffer_load_dwordx4 v9, s[16:19], s54 offen offset:0 lds
    v_mfma_f32_16x16x32_bf16 v[80:83], v[104:107], v[24:27], v[80:83]
    v_mfma_f32_16x16x32_bf16 v[84:87], v[104:107], v[40:43], v[84:87]
    v_mfma_f32_16x16x32_bf16 v[88:91], v[104:107], v[188:191], v[88:91]
    s_add_u32 m0, s57, 16320
    s_nop 0
    buffer_load_dwordx4 v9, s[16:19], s54 offen offset:64 lds
    s_add_u32 m0, s57, 4096
    s_nop 0
    buffer_load_dwordx4 v10, s[20:23], s55 offen offset:0 lds
    v_mfma_f32_16x16x32_bf16 v[80:83], v[108:111], v[28:31], v[80:83]
    v_mfma_f32_16x16x32_bf16 v[84:87], v[108:111], v[44:47], v[84:87]
    v_mfma_f32_16x16x32_bf16 v[88:91], v[108:111], v[188:191], v[88:91]
    s_add_u32 m0, s57, 8128
    s_nop 0
    buffer_load_dwordx4 v10, s[20:23], s55 offen offset:64 lds
    s_add_u32 m0, s57, 12160
    s_nop 0
    buffer_load_dwordx4 v10, s[20:23], s55 offen offset:128 lds
    v_mfma_f32_16x16x32_bf16 v[80:83], v[112:115], v[48:51], v[80:83]
    v_mfma_f32_16x16x32_bf16 v[84:87], v[112:115], v[64:67], v[84:87]
    v_mfma_f32_16x16x32_bf16 v[88:91], v[112:115], v[188:191], v[88:91]
    s_add_u32 m0, s57, 32576
    s_nop 0
    buffer_load_dwordx4 v10, s[20:23], s55 offen offset:192 lds
    v_mfma_f32_16x16x32_bf16 v[80:83], v[116:119], v[52:55], v[80:83]
    v_mfma_f32_16x16x32_bf16 v[84:87], v[116:119], v[68:71], v[84:87]
    v_mfma_f32_16x16x32_bf16 v[88:91], v[116:119], v[188:191], v[88:91]
    s_add_u32 m0, s57, 20224
    s_nop 0
    buffer_load_dwordx4 v10, s[20:23], s55 offen offset:256 lds
    s_add_u32 m0, s57, 24256
    s_nop 0
    buffer_load_dwordx4 v10, s[20:23], s55 offen offset:320 lds
    v_mfma_f32_16x16x32_bf16 v[80:83], v[120:123], v[56:59], v[80:83]
    v_mfma_f32_16x16x32_bf16 v[84:87], v[120:123], v[72:75], v[84:87]
    v_mfma_f32_16x16x32_bf16 v[88:91], v[120:123], v[188:191], v[88:91]
    s_add_u32 m0, s57, 28288
    s_nop 0
    buffer_load_dwordx4 v10, s[20:23], s55 offen offset:384 lds
    v_mfma_f32_16x16x32_bf16 v[80:83], v[124:127], v[60:63], v[80:83]
    v_mfma_f32_16x16x32_bf16 v[84:87], v[124:127], v[76:79], v[84:87]
    v_mfma_f32_16x16x32_bf16 v[88:91], v[124:127], v[188:191], v[88:91]
    s_waitcnt vmcnt(15)
    s_waitcnt lgkmcnt(0)
    s_barrier
    s_waitcnt vmcnt(13)
    s_nop 1
    v_mul_f32 v80, v232, v80
    s_nop 0
    v_fmac_f32 v80, v233, v88
    v_mul_f32 v81, v232, v81
    v_fmac_f32 v81, v233, v89
    v_mul_f32 v82, v232, v82
    v_fmac_f32 v82, v233, v90
    v_mul_f32 v83, v232, v83
    v_fmac_f32 v83, v233, v91
    v_mul_f32 v84, v234, v84
    v_fmac_f32 v84, v235, v88
    v_mul_f32 v85, v234, v85
    v_fmac_f32 v85, v235, v89
    v_mul_f32 v86, v234, v86
    v_fmac_f32 v86, v235, v90
    v_mul_f32 v87, v234, v87
    v_fmac_f32 v87, v235, v91
    s_and_b32 s47, s40, 1
    s_lshl_b32 s47, s47, 11
    s_add_u32 s47, s47, 159744
    v_add_u32 v13, s47, v5
    s_cmp_lt_u32 s40, 2
    s_cbranch_scc1 LA_r1
    ds_write_b128 v13, v[80:83]
    ds_write_b128 v13, v[84:87] offset:1024
LA_r1:
    s_add_u32 s69, 12, s68
    s_and_b32 s69, s69, 3
    s_cselect_b32 s69, 0, 4
    s_add_u32 s69, s69, 12
    s_add_u32 s69, s69, s46
    s_and_b32 s69, s69, 15
    s_lshl_b32 s53, s69, 7
    s_lshl_b32 s54, s69, 17
    s_mul_i32 s55, s69, 458752
    s_add_u32 s56, s51, 0
    s_add_u32 s57, s52, 0
    s_add_u32 m0, s56, 0
    s_nop 0
    buffer_load_dwordx4 v6, s[12:15], s53 offen lds
    s_add_u32 m0, s56, 1024
    s_nop 0
    buffer_load_dwordx4 v7, s[12:15], s53 offen lds
    s_add_u32 m0, s56, 2048
    s_nop 0
    buffer_load_dwordx4 v14, s[12:15], s53 offen lds
    s_add_u32 m0, s56, 3072
    s_nop 0
    buffer_load_dwordx4 v15, s[12:15], s53 offen lds
    s_add_u32 m0, s57, 0
    s_nop 0
    buffer_load_dwordx4 v9, s[16:19], s54 offen offset:0 lds
    s_add_u32 m0, s57, 16320
    s_nop 0
    buffer_load_dwordx4 v9, s[16:19], s54 offen offset:64 lds
    s_add_u32 m0, s57, 4096
    s_nop 0
    buffer_load_dwordx4 v10, s[20:23], s55 offen offset:0 lds
    s_add_u32 m0, s57, 8128
    s_nop 0
    buffer_load_dwordx4 v10, s[20:23], s55 offen offset:64 lds
    s_add_u32 m0, s57, 12160
    s_nop 0
    buffer_load_dwordx4 v10, s[20:23], s55 offen offset:128 lds
    s_add_u32 m0, s57, 32576
    s_nop 0
    buffer_load_dwordx4 v10, s[20:23], s55 offen offset:192 lds
    s_add_u32 m0, s57, 20224
    s_nop 0
    buffer_load_dwordx4 v10, s[20:23], s55 offen offset:256 lds
    s_add_u32 m0, s57, 24256
    s_nop 0
    buffer_load_dwordx4 v10, s[20:23], s55 offen offset:320 lds
    s_add_u32 m0, s57, 28288
    s_nop 0
    buffer_load_dwordx4 v10, s[20:23], s55 offen offset:384 lds
    s_waitcnt vmcnt(13)
    s_waitcnt lgkmcnt(0)
    s_barrier
    s_cmp_ge_u32 s40, 2
    s_cbranch_scc1 LA_r2
    ds_read_b128 v[232:235], v13
    ds_read_b128 v[236:239], v13 offset:1024
    s_waitcnt lgkmcnt(0)
    v_add_f32 v80, v80, v232
    v_add_f32 v81, v81, v233
    v_add_f32 v82, v82, v234
    v_add_f32 v83, v83, v235
    v_add_f32 v84, v84, v236
    v_add_f32 v85, v85, v237
    v_add_f32 v86, v86, v238
    v_add_f32 v87, v87, v239
    s_cmp_eq_u32 s40, 0
    s_cbranch_scc1 LA_r2
    ds_write_b128 v13, v[80:83]
    ds_write_b128 v13, v[84:87] offset:1024
LA_r2:
    s_add_u32 s69, 13, s68
    s_and_b32 s69, s69, 3
    s_cselect_b32 s69, 0, 4
    s_add_u32 s69, s69, 13
    s_add_u32 s69, s69, s46
    s_and_b32 s69, s69, 15
    s_lshl_b32 s53, s69, 7
    s_lshl_b32 s54, s69, 17
    s_mul_i32 s55, s69, 458752
    s_add_u32 s56, s51, 53248
    s_add_u32 s57, s52, 53248
    s_add_u32 m0, s56, 0
    s_nop 0
    buffer_load_dwordx4 v6, s[12:15], s53 offen lds
    s_add_u32 m0, s56, 1024
    s_nop 0
    buffer_load_dwordx4 v7, s[12:15], s53 offen lds
    s_add_u32 m0, s56, 2048
    s_nop 0
    buffer_load_dwordx4 v14, s[12:15], s53 offen lds
    s_add_u32 m0, s56, 3072
    s_nop 0
    buffer_load_dwordx4 v15, s[12:15], s53 offen lds
    s_add_u32 m0, s57, 0
    s_nop 0
    buffer_load_dwordx4 v9, s[16:19], s54 offen offset:0 lds
    s_add_u32 m0, s57, 16320
    s_nop 0
    buffer_load_dwordx4 v9, s[16:19], s54 offen offset:64 lds
    s_add_u32 m0, s57, 4096
    s_nop 0
    buffer_load_dwordx4 v10, s[20:23], s55 offen offset:0 lds
    s_add_u32 m0, s57, 8128
    s_nop 0
    buffer_load_dwordx4 v10, s[20:23], s55 offen offset:64 lds
    s_add_u32 m0, s57, 12160
    s_nop 0
    buffer_load_dwordx4 v10, s[20:23], s55 offen offset:128 lds
    s_add_u32 m0, s57, 32576
    s_nop 0
    buffer_load_dwordx4 v10, s[20:23], s55 offen offset:192 lds
    s_add_u32 m0, s57, 20224
    s_nop 0
    buffer_load_dwordx4 v10, s[20:23], s55 offen offset:256 lds
    s_add_u32 m0, s57, 24256
    s_nop 0
    buffer_load_dwordx4 v10, s[20:23], s55 offen offset:320 lds
    s_add_u32 m0, s57, 28288
    s_nop 0
    buffer_load_dwordx4 v10, s[20:23], s55 offen offset:384 lds
    s_mov_b32 s28, s10
    s_and_b32 s29, s11, 0xffff
    s_mov_b32 s30, 7168
    s_mov_b32 s31, 0x20000
    v_lshlrev_b32 v208, 3, v1
    s_mul_i32 s47, s42, 448
    buffer_load_dwordx2 v[248:249], v208, s[28:31], s47 offen
    s_waitcnt vmcnt(14)
    s_waitcnt lgkmcnt(0)
    s_barrier
    s_cmp_eq_u32 s40, 0
    s_cbranch_scc0 LA_kvd
    v_add_u32 v13, 2048, v13
    ds_read_b128 v[232:235], v13
    ds_read_b128 v[236:239], v13 offset:1024
    s_waitcnt lgkmcnt(0)
    v_add_f32 v80, v80, v232
    v_add_f32 v81, v81, v233
    v_add_f32 v82, v82, v234
    v_add_f32 v83, v83, v235
    v_add_f32 v84, v84, v236
    v_add_f32 v85, v85, v237
    v_add_f32 v86, v86, v238
    v_add_f32 v87, v87, v239
    v_mul_f32 v80, 0x407af233, v80
    v_mul_f32 v81, 0x407af233, v81
    v_mul_f32 v82, 0x407af233, v82
    v_mul_f32 v83, 0x407af233, v83
    v_mul_f32 v84, 0x407af233, v84
    v_mul_f32 v85, 0x407af233, v85
    v_mul_f32 v86, 0x407af233, v86
    v_mul_f32 v87, 0x407af233, v87
    v_cvt_pk_bf16_f32 v232, v80, v81
    v_cvt_pk_bf16_f32 v233, v82, v83
    v_cvt_pk_bf16_f32 v234, v84, v85
    v_cvt_pk_bf16_f32 v235, v86, v87
    s_lshl_b32 s38, s45, 12
    s_add_u32 s38, s38, 0x410000
    s_and_b32 s39, s44, 1
    s_cmp_ge_u32 s44, 2
    s_cbranch_scc1 LA_kvv
    v_and_b32 v11, 1, v4
    v_lshlrev_b32 v11, 9, v11
    v_lshl_add_u32 v11, v3, 4, v11
    v_lshrrev_b32 v12, 1, v4
    v_lshl_add_u32 v11, v12, 3, v11
    s_lshl_b32 s39, s39, 10
    s_add_u32 s38, s38, s39
    buffer_store_dwordx2 v[232:233], v11, s[24:27], s38 offen offset:0 sc1
    buffer_store_dwordx2 v[234:235], v11, s[24:27], s38 offen offset:256 sc1
    s_branch LA_kvd
LA_kvv:
    v_bfe_u32 v12, v3, 2, 1
    v_lshlrev_b32 v11, 8, v12
    v_lshl_add_u32 v11, v4, 6, v11
    v_lshrrev_b32 v12, 3, v3
    v_lshl_add_u32 v11, v12, 3, v11
    v_and_b32 v12, 3, v3
    v_lshl_add_u32 v11, v12, 1, v11
    v_add_u32 v11, 161792, v11
    ds_write_b16 v11, v232 offset:0
    ds_write_b16_d16_hi v11, v232 offset:16
    ds_write_b16 v11, v233 offset:32
    ds_write_b16_d16_hi v11, v233 offset:48
    ds_write_b16 v11, v234 offset:512
    ds_write_b16_d16_hi v11, v234 offset:528
    ds_write_b16 v11, v235 offset:544
    ds_write_b16_d16_hi v11, v235 offset:560
    ds_read_b128 v[236:239], v13
    v_lshlrev_b32 v11, 9, v4
    v_lshl_add_u32 v11, v3, 4, v11
    s_lshl_b32 s39, s39, 8
    s_add_u32 s38, s38, s39
    s_waitcnt lgkmcnt(0)
    buffer_store_dwordx4 v[236:239], v11, s[24:27], s38 offen offset:2048 sc1
LA_kvd:
    v_lshlrev_b32 v11, 2, v1
    v_add_u32 v11, 160256, v11
    ds_write_b32 v11, v219
    s_add_u32 s69, 14, s68
    s_and_b32 s69, s69, 3
    s_cselect_b32 s69, 0, 4
    s_add_u32 s69, s69, 14
    s_add_u32 s69, s69, s46
    s_and_b32 s69, s69, 15
    s_lshl_b32 s53, s69, 7
    s_lshl_b32 s54, s69, 17
    s_mul_i32 s55, s69, 458752
    s_add_u32 s56, s51, 106496
    s_add_u32 s57, s52, 106496
    s_add_u32 m0, s56, 0
    s_nop 0
    buffer_load_dwordx4 v6, s[12:15], s53 offen lds
    s_add_u32 m0, s56, 1024
    s_nop 0
    buffer_load_dwordx4 v7, s[12:15], s53 offen lds
    s_waitcnt vmcnt(2)
    s_add_u32 m0, s56, 2048
    s_nop 0
    buffer_load_dwordx4 v14, s[12:15], s53 offen lds
    v_lshlrev_b32 v240, 16, v248
    s_add_u32 m0, s56, 3072
    s_nop 0
    buffer_load_dwordx4 v15, s[12:15], s53 offen lds
    s_add_u32 m0, s57, 0
    s_nop 0
    buffer_load_dwordx4 v9, s[16:19], s54 offen offset:0 lds
    v_and_b32 v241, 0xffff0000, v248
    s_add_u32 m0, s57, 16320
    s_nop 0
    buffer_load_dwordx4 v9, s[16:19], s54 offen offset:64 lds
    v_lshlrev_b32 v242, 16, v249
    s_add_u32 m0, s57, 4096
    s_nop 0
    buffer_load_dwordx4 v10, s[20:23], s55 offen offset:0 lds
    s_add_u32 m0, s57, 8128
    s_nop 0
    buffer_load_dwordx4 v10, s[20:23], s55 offen offset:64 lds
    v_and_b32 v243, 0xffff0000, v249
    s_add_u32 m0, s57, 12160
    s_nop 0
    buffer_load_dwordx4 v10, s[20:23], s55 offen offset:128 lds
    v_mul_f32 v240, 0x3eeff558, v240
    s_add_u32 m0, s57, 32576
    s_nop 0
    buffer_load_dwordx4 v10, s[20:23], s55 offen offset:192 lds
    s_add_u32 m0, s57, 20224
    s_nop 0
    buffer_load_dwordx4 v10, s[20:23], s55 offen offset:256 lds
    v_mul_f32 v241, 0x3eeff558, v241
    s_add_u32 m0, s57, 24256
    s_nop 0
    buffer_load_dwordx4 v10, s[20:23], s55 offen offset:320 lds
    v_mul_f32 v242, 0x3eeff558, v242
    s_add_u32 m0, s57, 28288
    s_nop 0
    buffer_load_dwordx4 v10, s[20:23], s55 offen offset:384 lds
    v_mul_f32 v243, 0x3eeff558, v243
    s_waitcnt vmcnt(14)
    s_waitcnt lgkmcnt(0)
    s_barrier
    s_cmp_eq_u32 s40, 0
    s_cbranch_scc0 LA_np0
    s_lshl_b32 s38, s41, 12
    s_lshl_b32 s39, s42, 2
    s_add_u32 s38, s38, s39
    s_add_u32 s38, s38, 0x2e00c00
    s_waitcnt vmcnt(0)
    s_mov_b64 exec, 1
    buffer_store_dword v217, v219, s[24:27], s38 offen sc1
    s_mov_b64 exec, -1
LA_np0:
    buffer_load_dword v218, v224, s[24:27], s65 offen sc1
    s_add_u32 s69, 15, s68
    s_and_b32 s69, s69, 3
    s_cselect_b32 s69, 0, 4
    s_add_u32 s69, s69, 15
    s_add_u32 s69, s69, s46
    s_and_b32 s69, s69, 15
    s_lshl_b32 s53, s69, 7
    s_lshl_b32 s54, s69, 17
    s_mul_i32 s55, s69, 458752
    s_add_u32 s56, s51, 0
    s_add_u32 s57, s52, 0
    s_add_u32 m0, s56, 0
    s_nop 0
    buffer_load_dwordx4 v6, s[12:15], s53 offen lds
    s_add_u32 m0, s56, 1024
    s_nop 0
    buffer_load_dwordx4 v7, s[12:15], s53 offen lds
    s_add_u32 m0, s56, 2048
    s_nop 0
    buffer_load_dwordx4 v14, s[12:15], s53 offen lds
    s_add_u32 m0, s56, 3072
    s_nop 0
    buffer_load_dwordx4 v15, s[12:15], s53 offen lds
    s_add_u32 m0, s57, 0
    s_nop 0
    buffer_load_dwordx4 v9, s[16:19], s54 offen offset:0 lds
    s_add_u32 m0, s57, 16320
    s_nop 0
    buffer_load_dwordx4 v9, s[16:19], s54 offen offset:64 lds
    s_add_u32 m0, s57, 4096
    s_nop 0
    buffer_load_dwordx4 v10, s[20:23], s55 offen offset:0 lds
    s_add_u32 m0, s57, 8128
    s_nop 0
    buffer_load_dwordx4 v10, s[20:23], s55 offen offset:64 lds
    s_add_u32 m0, s57, 12160
    s_nop 0
    buffer_load_dwordx4 v10, s[20:23], s55 offen offset:128 lds
    s_add_u32 m0, s57, 32576
    s_nop 0
    buffer_load_dwordx4 v10, s[20:23], s55 offen offset:192 lds
    s_add_u32 m0, s57, 20224
    s_nop 0
    buffer_load_dwordx4 v10, s[20:23], s55 offen offset:256 lds
    s_add_u32 m0, s57, 24256
    s_nop 0
    buffer_load_dwordx4 v10, s[20:23], s55 offen offset:320 lds
    s_add_u32 m0, s57, 28288
    s_nop 0
    buffer_load_dwordx4 v10, s[20:23], s55 offen offset:384 lds
    s_waitcnt vmcnt(14)
    s_waitcnt vmcnt(13)
    v_cmp_ne_u32 vcc, 1, v218
    s_nop 4
    s_cbranch_vccnz LA_p4_s
LA_p4_r:
    s_waitcnt lgkmcnt(0)
    s_barrier
    ds_write_b128 v5, v[240:243] offset:55296
    s_lshl_b32 s47, s40, 10
    s_add_u32 m0, s47, 57344
    s_lshl_b32 s48, s41, 12
    s_add_u32 s47, s47, s48
    s_add_u32 s47, s47, 0x400000
    buffer_load_dwordx4 v5, s[24:27], s47 offen sc1 lds
    s_cmp_lt_u32 s40, 2
    s_cselect_b32 s47, 31, 7
    v_and_b32 v207, s47, v1
    v_lshlrev_b32 v207, 4, v207
    v_lshl_add_u32 v208, v204, 11, v207
    s_lshl_b32 s58, s42, 15
    s_min_u32 s48, s40, 2
    s_lshl_b32 s48, s48, 9
    s_add_u32 s58, s58, s48
    buffer_load_dwordx4 v[128:131], v208, s[24:27], s58 offen sc1
    s_add_u32 s58, s58, 4096
    buffer_load_dwordx4 v[132:135], v208, s[24:27], s58 offen sc1
    s_add_u32 s58, s58, 4096
    buffer_load_dwordx4 v[136:139], v208, s[24:27], s58 offen sc1
    s_add_u32 s58, s58, 4096
    buffer_load_dwordx4 v[140:143], v208, s[24:27], s58 offen sc1
    s_add_u32 s58, s58, 4096
    buffer_load_dwordx4 v[144:147], v208, s[24:27], s58 offen sc1
    s_add_u32 s58, s58, 4096
    buffer_load_dwordx4 v[148:151], v208, s[24:27], s58 offen sc1
    s_add_u32 s58, s58, 4096
    buffer_load_dwordx4 v[152:155], v208, s[24:27], s58 offen sc1
    s_add_u32 s58, s58, 4096
    buffer_load_dwordx4 v[156:159], v208, s[24:27], s58 offen sc1
    s_add_u32 s58, s58, 4096
    s_waitcnt vmcnt(0)
    v_add_f32 v128, v128, v132
    v_add_f32 v129, v129, v133
    v_add_f32 v130, v130, v134
    v_add_f32 v131, v131, v135
    v_add_f32 v128, v128, v136
    v_add_f32 v129, v129, v137
    v_add_f32 v130, v130, v138
    v_add_f32 v131, v131, v139
    v_add_f32 v128, v128, v140
    v_add_f32 v129, v129, v141
    v_add_f32 v130, v130, v142
    v_add_f32 v131, v131, v143
    v_add_f32 v128, v128, v144
    v_add_f32 v129, v129, v145
    v_add_f32 v130, v130, v146
    v_add_f32 v131, v131, v147
    v_add_f32 v128, v128, v148
    v_add_f32 v129, v129, v149
    v_add_f32 v130, v130, v150
    v_add_f32 v131, v131, v151
    v_add_f32 v128, v128, v152
    v_add_f32 v129, v129, v153
    v_add_f32 v130, v130, v154
    v_add_f32 v131, v131, v155
    v_add_f32 v128, v128, v156
    v_add_f32 v129, v129, v157
    v_add_f32 v130, v130, v158
    v_add_f32 v131, v131, v159
    v_mov_b32 v132, v128
    v_mov_b32 v133, v129
    v_mov_b32 v134, v130
    v_mov_b32 v135, v131
    v_permlane32_swap_b32 v128, v132
    v_permlane32_swap_b32 v129, v133
    v_permlane32_swap_b32 v130, v134
    v_permlane32_swap_b32 v131, v135
    v_add_f32 v128, v128, v132
    v_add_f32 v129, v129, v133
    v_add_f32 v130, v130, v134
    v_add_f32 v131, v131, v135
    s_add_u32 s47, s48, 53248
    v_add_u32 v207, s47, v207
    ds_write_b128 v207, v[128:131]
    s_lshl_b32 s39, s40, 2
    s_add_u32 s39, s39, 160256
    v_mov_b32 v254, s39
    s_waitcnt lgkmcnt(0)
    s_barrier
    s_load_dwordx2 s[4:5], s[0:1], 32
    v_lshlrev_b32 v6, 4, v3
    v_lshrrev_b32 v7, 5, v1
    v_lshl_add_u32 v6, v7, 8, v6
    v_bfe_u32 v8, v1, 4, 1
    s_mov_b32 s44, 147456
    v_mul_lo_u32 v7, v8, s44
    v_add_u32 v7, v7, v6
    v_lshl_add_u32 v6, v8, 11, v6
    s_add_u32 s47, s51, 143360
    v_add_u32 v6, s47, v6
    s_lshl_b32 s45, s41, 2
    s_add_u32 s45, s45, s40
    s_mul_i32 s47, s45, 294912
    s_lshl_b32 s46, s42, 11
    s_add_u32 s47, s47, s46
    s_add_u32 s47, s47, 0x1000000
    s_lshl_b32 s53, s41, 12
    s_lshl_b32 s54, s40, 7
    s_add_u32 s53, s53, s54
    s_lshl_b32 s54, s42, 2
    s_add_u32 s53, s53, s54
    s_add_u32 s53, s53, 0x2e00800
    s_add_u32 s12, s6, 0x410000
    s_addc_u32 s13, s7, 0
    s_and_b32 s13, s13, 0xffff
    s_mov_b32 s14, 0x40000
    s_mov_b32 s15, 0x20000
    v_and_b32 v8, 4, v1
    v_cmp_eq_u32 vcc, 0, v8
    v_mov_b32 v9, 0x3f803f80
    v_mov_b32 v8, 0
    v_cndmask_b32 v152, v8, v9, vcc
    v_cndmask_b32 v153, v8, v9, vcc
    v_cndmask_b32 v154, v9, v8, vcc
    v_cndmask_b32 v155, v9, v8, vcc
    v_and_b32 v8, 1, v1
    v_mul_u32_u24 v8, 0xaaaa, v8
    v_add_u32 v200, 0x4444, v8
    v_mov_b64 v[112:113], 0
    v_mov_b64 v[114:115], 0
    v_mov_b64 v[116:117], 0
    v_mov_b64 v[118:119], 0
    v_mov_b64 v[120:121], 0
    v_mov_b64 v[122:123], 0
    v_mov_b64 v[124:125], 0
    v_mov_b64 v[126:127], 0
    v_mov_b64 v[144:145], 0
    v_mov_b64 v[146:147], 0
    v_mov_b64 v[128:129], 0
    v_mov_b64 v[130:131], 0
    v_mov_b64 v[132:133], 0
    v_mov_b64 v[134:135], 0
    v_mov_b64 v[136:137], 0
    v_mov_b64 v[138:139], 0
    v_mov_b64 v[140:141], 0
    v_mov_b64 v[142:143], 0
    v_mov_b64 v[148:149], 0
    v_mov_b64 v[150:151], 0
    v_mov_b64 v[104:105], 0
    v_mov_b64 v[180:181], 0
    v_mov_b64 v[106:107], 0
    v_mov_b64 v[182:183], 0
    v_mov_b64 v[108:109], 0
    v_mov_b64 v[184:185], 0
    v_mov_b64 v[110:111], 0
    v_mov_b64 v[186:187], 0
    v_mov_b32 v201, 1
    v_lshlrev_b32 v12, 7, v1
    s_waitcnt lgkmcnt(0)
    s_mov_b32 s20, s4
    s_and_b32 s21, s5, 0xffff
    s_mov_b32 s22, 0x200000
    s_mov_b32 s23, 0x20000
    s_lshl_b32 s55, s2, 13
    s_getpc_b64 s[16:17]
Lpc_1:
    s_add_u32 s16, s16, LG_tail-Lpc_1
    s_addc_u32 s17, s17, 0
    v_lshlrev_b32 v10, 7, v1
    v_add_u32 v10, 0, v10
    v_min_u32 v10, Lcode_end-LG_tail-4, v10
    v_mov_b32 v11, s17
    v_add_co_u32 v10, vcc, s16, v10
    s_nop 1
    v_addc_co_u32 v11, vcc, 0, v11, vcc
    s_cmp_eq_u32 s40, 1
    s_cbranch_scc0 LA_np
    v_lshrrev_b32 v13, 2, v1
    v_lshlrev_b32 v13, 12, v13
    v_and_b32 v14, 3, v1
    v_lshl_add_u32 v13, v14, 4, v13
    s_mov_b32 s48, 0x2e00c00
    s_mov_b32 s58, 0
LA_p3:
    buffer_load_dwordx4 v[188:191], v13, s[24:27], s48 offen sc1
    s_add_u32 s58, s58, 1
    s_waitcnt vmcnt(0)
    v_and_b32 v188, v188, v189
    v_and_b32 v188, v188, v190
    v_and_b32 v188, v188, v191
    v_cmp_ne_u32 vcc, 1, v188
    s_nop 4
    s_cbranch_vccz LA_p3_ok
    s_sleep 4
    s_cmp_lt_u32 s58, 1000000
    s_cbranch_scc1 LA_p3
LA_p3_ok:
    ds_write_b32 v255, v201 offset:32
LA_np:
    s_mov_b32 s3, 0
LA_w3:
    ds_read_b32 v13, v255 offset:32
    s_add_u32 s3, s3, 1
    s_waitcnt lgkmcnt(0)
    v_cmp_gt_u32 vcc, 1, v13
    s_nop 4
    s_cbranch_vccz LA_w3_ok
    s_sleep 1
    s_cmp_lt_u32 s3, 8000000
    s_cbranch_scc1 LA_w3
LA_w3_ok:
    s_mov_b32 s3, 0
LA_w2:
    ds_read_b32 v13, v255 offset:16
    s_add_u32 s3, s3, 1
    s_waitcnt lgkmcnt(0)
    v_cmp_gt_u32 vcc, 1, v13
    s_nop 4
    s_cbranch_vccz LA_w2_ok
    s_sleep 1
    s_cmp_lt_u32 s3, 8000000
    s_cbranch_scc1 LA_w2
LA_w2_ok:
    ds_read_b128 v[16:19], v6 offset:0
    ds_read_b128 v[20:23], v6 offset:512
    ds_read_b128 v[24:27], v6 offset:1024
    ds_read_b128 v[28:31], v6 offset:1536
    s_setprio 1
    s_lshl_b32 s50, s40, 11
    s_mov_b32 s51, s50
    s_add_u32 m0, s51, 0
    s_nop 0
    buffer_load_dwordx4 v5, s[12:15], s50 offen sc1 lds
    buffer_load_dwordx4 v5, s[12:15], s50 offen offset:1024 sc1 lds
    s_add_u32 s50, s50, 0x2000
    s_add_u32 m0, s51, 8192
    s_nop 0
    buffer_load_dwordx4 v5, s[12:15], s50 offen sc1 lds
    buffer_load_dwordx4 v5, s[12:15], s50 offen offset:1024 sc1 lds
    s_add_u32 s50, s50, 0x2000
    s_add_u32 m0, s51, 16384
    s_nop 0
    buffer_load_dwordx4 v5, s[12:15], s50 offen sc1 lds
    buffer_load_dwordx4 v5, s[12:15], s50 offen offset:1024 sc1 lds
    s_add_u32 s50, s50, 0x2000
    s_waitcnt vmcnt(4)
    ds_write_b32 v254, v201 offset:48
    s_mov_b32 s3, 0
LA_w4:
    ds_read_b32 v13, v255 offset:48
    s_add_u32 s3, s3, 1
    s_waitcnt lgkmcnt(0)
    v_cmp_gt_u32 vcc, 1, v13
    s_nop 4
    s_cbranch_vccz LA_w4_ok
    s_sleep 1
    s_cmp_lt_u32 s3, 8000000
    s_cbranch_scc1 LA_w4
LA_w4_ok:
    ds_read_b128 v[156:159], v5 offset:0
    ds_read_b128 v[160:163], v5 offset:1024
    v_add_u32 v201, 1, v201
    s_waitcnt vmcnt(2)
    ds_write_b32 v254, v201 offset:48
    s_waitcnt lgkmcnt(0)
    v_mfma_f32_32x32x16_bf16 v[64:79], v[156:159], v[16:19], 0
    v_mfma_f32_32x32x16_bf16 v[64:79], v[160:163], v[20:23], v[64:79]
    v_mfma_f32_32x32x16_bf16 v[80:95], v[156:159], v[24:27], 0
    v_mfma_f32_32x32x16_bf16 v[80:95], v[160:163], v[28:31], v[80:95]
    s_nop 9
    v_max3_f32 v188, v64, v65, v66
    v_max_f32 v188, v188, v67
    v_max3_f32 v188, v188, v68, v69
    v_max3_f32 v188, v188, v70, v71
    v_max3_f32 v188, v188, v72, v73
    v_max3_f32 v188, v188, v74, v75
    v_max3_f32 v188, v188, v76, v77
    v_max3_f32 v188, v188, v78, v79
    v_mov_b32 v196, v188
    s_nop 1
    v_permlane32_swap_b32 v188, v196
    v_max_f32 v188, v188, v196
    v_sub_f32 v32, 0, v188
    v_sub_f32 v33, 0, v188
    v_sub_f32 v34, 0, v188
    v_sub_f32 v35, 0, v188
    v_sub_f32 v36, 0, v188
    v_sub_f32 v37, 0, v188
    v_sub_f32 v38, 0, v188
    v_sub_f32 v39, 0, v188
    v_sub_f32 v40, 0, v188
    v_sub_f32 v41, 0, v188
    v_sub_f32 v42, 0, v188
    v_sub_f32 v43, 0, v188
    v_sub_f32 v44, 0, v188
    v_sub_f32 v45, 0, v188
    v_sub_f32 v46, 0, v188
    v_sub_f32 v47, 0, v188
    v_max3_f32 v189, v80, v81, v82
    v_max_f32 v189, v189, v83
    v_max3_f32 v189, v189, v84, v85
    v_max3_f32 v189, v189, v86, v87
    v_max3_f32 v189, v189, v88, v89
    v_max3_f32 v189, v189, v90, v91
    v_max3_f32 v189, v189, v92, v93
    v_max3_f32 v189, v189, v94, v95
    v_mov_b32 v196, v189
    s_nop 1
    v_permlane32_swap_b32 v189, v196
    v_max_f32 v189, v189, v196
    v_sub_f32 v48, 0, v189
    v_sub_f32 v49, 0, v189
    v_sub_f32 v50, 0, v189
    v_sub_f32 v51, 0, v189
    v_sub_f32 v52, 0, v189
    v_sub_f32 v53, 0, v189
    v_sub_f32 v54, 0, v189
    v_sub_f32 v55, 0, v189
    v_sub_f32 v56, 0, v189
    v_sub_f32 v57, 0, v189
    v_sub_f32 v58, 0, v189
    v_sub_f32 v59, 0, v189
    v_sub_f32 v60, 0, v189
    v_sub_f32 v61, 0, v189
    v_sub_f32 v62, 0, v189
    v_sub_f32 v63, 0, v189
    v_mfma_f32_32x32x16_bf16 v[64:79], v[156:159], v[16:19], v[32:47]
    v_mfma_f32_32x32x16_bf16 v[64:79], v[160:163], v[20:23], v[64:79]
    s_mov_b32 s59, 0
    s_nop 15
    .p2align 6
LA_loop:
    v_mfma_f32_32x32x16_bf16 v[80:95], v[156:159], v[24:27], v[48:63]
    ds_read_b128 v[164:167], v5 offset:4096
    v_exp_f32 v64, v64
    v_exp_f32 v65, v65
    v_exp_f32 v66, v66
    v_exp_f32 v67, v67
    v_mfma_f32_32x32x16_bf16 v[80:95], v[160:163], v[28:31], v[80:95]
    ds_read_b128 v[168:171], v5 offset:5120
    v_cvt_pk_bf16_f32 v96, v64, v65
    v_exp_f32 v68, v68
    v_exp_f32 v69, v69
    v_cvt_pk_bf16_f32 v97, v66, v67
    v_exp_f32 v70, v70
    v_mfma_f32_32x32x16_bf16 v[128:143], v[180:183], v[104:107], v[128:143]
    ds_read_b128 v[172:175], v5 offset:2048
    v_exp_f32 v71, v71
    v_cvt_pk_bf16_f32 v98, v68, v69
    v_exp_f32 v72, v72
    v_exp_f32 v73, v73
    v_cvt_pk_bf16_f32 v99, v70, v71
    v_mfma_f32_32x32x16_bf16 v[128:143], v[184:187], v[108:111], v[128:143]
    ds_read_b128 v[176:179], v5 offset:3072
    v_exp_f32 v74, v74
    v_exp_f32 v75, v75
    v_cvt_pk_bf16_f32 v100, v72, v73
    v_exp_f32 v76, v76
    v_exp_f32 v77, v77
    v_smfmac_f32_16x16x64_bf16 v[148:151], v[152:155], v[104:111], v200
    ds_read_b32 v202, v255 offset:48
    v_cvt_pk_bf16_f32 v101, v74, v75
    v_exp_f32 v78, v78
    v_exp_f32 v79, v79
    v_cvt_pk_bf16_f32 v102, v76, v77
    v_cvt_pk_bf16_f32 v103, v78, v79
    s_waitcnt lgkmcnt(0)
    v_mfma_f32_32x32x16_bf16 v[64:79], v[164:167], v[16:19], v[32:47]
    v_cmp_gt_u32 vcc, v201, v202
    v_exp_f32 v80, v80
    v_exp_f32 v81, v81
    v_exp_f32 v82, v82
    v_exp_f32 v83, v83
    v_mfma_f32_32x32x16_bf16 v[64:79], v[168:171], v[20:23], v[64:79]
    s_cbranch_vccnz LA_sp0
LA_spr0:
    v_cvt_pk_bf16_f32 v104, v80, v81
    v_exp_f32 v84, v84
    v_exp_f32 v85, v85
    v_cvt_pk_bf16_f32 v105, v82, v83
    v_exp_f32 v86, v86
    v_mfma_f32_32x32x16_bf16 v[112:127], v[172:175], v[96:99], v[112:127]
    s_add_u32 m0, s51, 24576
    v_exp_f32 v87, v87
    v_cvt_pk_bf16_f32 v106, v84, v85
    v_exp_f32 v88, v88
    v_exp_f32 v89, v89
    v_cvt_pk_bf16_f32 v107, v86, v87
    v_mfma_f32_32x32x16_bf16 v[112:127], v[176:179], v[100:103], v[112:127]
    buffer_load_dwordx4 v5, s[12:15], s50 offen sc1 lds
    v_exp_f32 v90, v90
    v_exp_f32 v91, v91
    v_cvt_pk_bf16_f32 v108, v88, v89
    v_exp_f32 v92, v92
    v_exp_f32 v93, v93
    v_smfmac_f32_16x16x64_bf16 v[144:147], v[152:155], v[96:103], v200
    buffer_load_dwordx4 v5, s[12:15], s50 offen offset:1024 sc1 lds
    s_add_u32 s50, s50, 0x2000
    v_cvt_pk_bf16_f32 v109, v90, v91
    v_exp_f32 v94, v94
    v_exp_f32 v95, v95
    v_cvt_pk_bf16_f32 v110, v92, v93
    v_cvt_pk_bf16_f32 v111, v94, v95
    v_mfma_f32_32x32x16_bf16 v[80:95], v[164:167], v[24:27], v[48:63]
    ds_read_b128 v[156:159], v5 offset:8192
    v_exp_f32 v64, v64
    v_exp_f32 v65, v65
    v_exp_f32 v66, v66
    v_exp_f32 v67, v67
    v_mfma_f32_32x32x16_bf16 v[80:95], v[168:171], v[28:31], v[80:95]
    ds_read_b128 v[160:163], v5 offset:9216
    v_cvt_pk_bf16_f32 v96, v64, v65
    v_exp_f32 v68, v68
    v_exp_f32 v69, v69
    v_cvt_pk_bf16_f32 v97, v66, v67
    v_exp_f32 v70, v70
    v_mfma_f32_32x32x16_bf16 v[128:143], v[172:175], v[104:107], v[128:143]
    ds_read_b128 v[180:183], v5 offset:6144
    v_exp_f32 v71, v71
    v_cvt_pk_bf16_f32 v98, v68, v69
    v_exp_f32 v72, v72
    v_exp_f32 v73, v73
    v_cvt_pk_bf16_f32 v99, v70, v71
    v_mfma_f32_32x32x16_bf16 v[128:143], v[176:179], v[108:111], v[128:143]
    ds_read_b128 v[184:187], v5 offset:7168
    v_exp_f32 v74, v74
    v_exp_f32 v75, v75
    v_cvt_pk_bf16_f32 v100, v72, v73
    v_exp_f32 v76, v76
    v_exp_f32 v77, v77
    v_smfmac_f32_16x16x64_bf16 v[148:151], v[152:155], v[104:111], v200
    v_cvt_pk_bf16_f32 v101, v74, v75
    v_exp_f32 v78, v78
    v_exp_f32 v79, v79
    v_cvt_pk_bf16_f32 v102, v76, v77
    v_cvt_pk_bf16_f32 v103, v78, v79
    s_waitcnt lgkmcnt(0)
    v_mfma_f32_32x32x16_bf16 v[64:79], v[156:159], v[16:19], v[32:47]
    v_add_u32 v201, 1, v201
    v_exp_f32 v80, v80
    v_exp_f32 v81, v81
    v_exp_f32 v82, v82
    v_exp_f32 v83, v83
    v_mfma_f32_32x32x16_bf16 v[64:79], v[160:163], v[20:23], v[64:79]
    s_waitcnt vmcnt(2)
    ds_write_b32 v254, v201 offset:48
    v_cvt_pk_bf16_f32 v104, v80, v81
    v_exp_f32 v84, v84
    v_exp_f32 v85, v85
    v_cvt_pk_bf16_f32 v105, v82, v83
    v_exp_f32 v86, v86
    v_mfma_f32_32x32x16_bf16 v[112:127], v[180:183], v[96:99], v[112:127]
    v_exp_f32 v87, v87
    v_cvt_pk_bf16_f32 v106, v84, v85
    v_exp_f32 v88, v88
    v_exp_f32 v89, v89
    v_cvt_pk_bf16_f32 v107, v86, v87
    v_mfma_f32_32x32x16_bf16 v[112:127], v[184:187], v[100:103], v[112:127]
    v_exp_f32 v90, v90
    v_exp_f32 v91, v91
    v_cvt_pk_bf16_f32 v108, v88, v89
    v_exp_f32 v92, v92
    v_exp_f32 v93, v93
    v_smfmac_f32_16x16x64_bf16 v[144:147], v[152:155], v[96:103], v200
    v_cvt_pk_bf16_f32 v109, v90, v91
    v_exp_f32 v94, v94
    v_exp_f32 v95, v95
    v_cvt_pk_bf16_f32 v110, v92, v93
    v_cvt_pk_bf16_f32 v111, v94, v95
    v_mfma_f32_32x32x16_bf16 v[80:95], v[156:159], v[24:27], v[48:63]
    ds_read_b128 v[164:167], v5 offset:12288
    v_exp_f32 v64, v64
    v_exp_f32 v65, v65
    v_exp_f32 v66, v66
    v_exp_f32 v67, v67
    v_mfma_f32_32x32x16_bf16 v[80:95], v[160:163], v[28:31], v[80:95]
    ds_read_b128 v[168:171], v5 offset:13312
    v_cvt_pk_bf16_f32 v96, v64, v65
    v_exp_f32 v68, v68
    v_exp_f32 v69, v69
    v_cvt_pk_bf16_f32 v97, v66, v67
    v_exp_f32 v70, v70
    v_mfma_f32_32x32x16_bf16 v[128:143], v[180:183], v[104:107], v[128:143]
    ds_read_b128 v[172:175], v5 offset:10240
    v_exp_f32 v71, v71
    v_cvt_pk_bf16_f32 v98, v68, v69
    v_exp_f32 v72, v72
    v_exp_f32 v73, v73
    v_cvt_pk_bf16_f32 v99, v70, v71
    v_mfma_f32_32x32x16_bf16 v[128:143], v[184:187], v[108:111], v[128:143]
    ds_read_b128 v[176:179], v5 offset:11264
    v_exp_f32 v74, v74
    v_exp_f32 v75, v75
    v_cvt_pk_bf16_f32 v100, v72, v73
    v_exp_f32 v76, v76
    v_exp_f32 v77, v77
    v_smfmac_f32_16x16x64_bf16 v[148:151], v[152:155], v[104:111], v200
    ds_read_b32 v202, v255 offset:48
    v_cvt_pk_bf16_f32 v101, v74, v75
    v_exp_f32 v78, v78
    v_exp_f32 v79, v79
    v_cvt_pk_bf16_f32 v102, v76, v77
    v_cvt_pk_bf16_f32 v103, v78, v79
    s_waitcnt lgkmcnt(0)
    v_mfma_f32_32x32x16_bf16 v[64:79], v[164:167], v[16:19], v[32:47]
    v_cmp_gt_u32 vcc, v201, v202
    v_exp_f32 v80, v80
    v_exp_f32 v81, v81
    v_exp_f32 v82, v82
    v_exp_f32 v83, v83
    v_mfma_f32_32x32x16_bf16 v[64:79], v[168:171], v[20:23], v[64:79]
    s_cbranch_vccnz LA_sp1
LA_spr1:
    v_cvt_pk_bf16_f32 v104, v80, v81
    v_exp_f32 v84, v84
    v_exp_f32 v85, v85
    v_cvt_pk_bf16_f32 v105, v82, v83
    v_exp_f32 v86, v86
    v_mfma_f32_32x32x16_bf16 v[112:127], v[172:175], v[96:99], v[112:127]
    s_add_u32 m0, s51, 0
    v_exp_f32 v87, v87
    v_cvt_pk_bf16_f32 v106, v84, v85
    v_exp_f32 v88, v88
    v_exp_f32 v89, v89
    v_cvt_pk_bf16_f32 v107, v86, v87
    v_mfma_f32_32x32x16_bf16 v[112:127], v[176:179], v[100:103], v[112:127]
    buffer_load_dwordx4 v5, s[12:15], s50 offen sc1 lds
    v_exp_f32 v90, v90
    v_exp_f32 v91, v91
    v_cvt_pk_bf16_f32 v108, v88, v89
    v_exp_f32 v92, v92
    v_exp_f32 v93, v93
    v_smfmac_f32_16x16x64_bf16 v[144:147], v[152:155], v[96:103], v200
    buffer_load_dwordx4 v5, s[12:15], s50 offen offset:1024 sc1 lds
    s_add_u32 s50, s50, 0x2000
    v_cvt_pk_bf16_f32 v109, v90, v91
    v_exp_f32 v94, v94
    v_exp_f32 v95, v95
    v_cvt_pk_bf16_f32 v110, v92, v93
    v_cvt_pk_bf16_f32 v111, v94, v95
    v_mfma_f32_32x32x16_bf16 v[80:95], v[164:167], v[24:27], v[48:63]
    ds_read_b128 v[156:159], v5 offset:16384
    v_exp_f32 v64, v64
    v_exp_f32 v65, v65
    v_exp_f32 v66, v66
    v_exp_f32 v67, v67
    v_mfma_f32_32x32x16_bf16 v[80:95], v[168:171], v[28:31], v[80:95]
    ds_read_b128 v[160:163], v5 offset:17408
    v_cvt_pk_bf16_f32 v96, v64, v65
    v_exp_f32 v68, v68
    v_exp_f32 v69, v69
    v_cvt_pk_bf16_f32 v97, v66, v67
    v_exp_f32 v70, v70
    v_mfma_f32_32x32x16_bf16 v[128:143], v[172:175], v[104:107], v[128:143]
    ds_read_b128 v[180:183], v5 offset:14336
    v_exp_f32 v71, v71
    v_cvt_pk_bf16_f32 v98, v68, v69
    v_exp_f32 v72, v72
    v_exp_f32 v73, v73
    v_cvt_pk_bf16_f32 v99, v70, v71
    v_mfma_f32_32x32x16_bf16 v[128:143], v[176:179], v[108:111], v[128:143]
    ds_read_b128 v[184:187], v5 offset:15360
    v_exp_f32 v74, v74
    v_exp_f32 v75, v75
    v_cvt_pk_bf16_f32 v100, v72, v73
    v_exp_f32 v76, v76
    v_exp_f32 v77, v77
    v_smfmac_f32_16x16x64_bf16 v[148:151], v[152:155], v[104:111], v200
    v_cvt_pk_bf16_f32 v101, v74, v75
    v_exp_f32 v78, v78
    v_exp_f32 v79, v79
    v_cvt_pk_bf16_f32 v102, v76, v77
    v_cvt_pk_bf16_f32 v103, v78, v79
    s_waitcnt lgkmcnt(0)
    v_mfma_f32_32x32x16_bf16 v[64:79], v[156:159], v[16:19], v[32:47]
    v_add_u32 v201, 1, v201
    v_exp_f32 v80, v80
    v_exp_f32 v81, v81
    v_exp_f32 v82, v82
    v_exp_f32 v83, v83
    v_mfma_f32_32x32x16_bf16 v[64:79], v[160:163], v[20:23], v[64:79]
    s_waitcnt vmcnt(2)
    ds_write_b32 v254, v201 offset:48
    v_cvt_pk_bf16_f32 v104, v80, v81
    v_exp_f32 v84, v84
    v_exp_f32 v85, v85
    v_cvt_pk_bf16_f32 v105, v82, v83
    v_exp_f32 v86, v86
    v_mfma_f32_32x32x16_bf16 v[112:127], v[180:183], v[96:99], v[112:127]
    v_exp_f32 v87, v87
    v_cvt_pk_bf16_f32 v106, v84, v85
    v_exp_f32 v88, v88
    v_exp_f32 v89, v89
    v_cvt_pk_bf16_f32 v107, v86, v87
    v_mfma_f32_32x32x16_bf16 v[112:127], v[184:187], v[100:103], v[112:127]
    s_cmp_eq_u32 s59, 3
    s_cbranch_scc1 LA_xt
LA_xtr:
    v_exp_f32 v90, v90
    v_exp_f32 v91, v91
    v_cvt_pk_bf16_f32 v108, v88, v89
    v_exp_f32 v92, v92
    v_exp_f32 v93, v93
    v_smfmac_f32_16x16x64_bf16 v[144:147], v[152:155], v[96:103], v200
    v_cvt_pk_bf16_f32 v109, v90, v91
    v_exp_f32 v94, v94
    v_exp_f32 v95, v95
    v_cvt_pk_bf16_f32 v110, v92, v93
    v_cvt_pk_bf16_f32 v111, v94, v95
    v_mfma_f32_32x32x16_bf16 v[80:95], v[156:159], v[24:27], v[48:63]
    ds_read_b128 v[164:167], v5 offset:20480
    v_exp_f32 v64, v64
    v_exp_f32 v65, v65
    v_exp_f32 v66, v66
    v_exp_f32 v67, v67
    v_mfma_f32_32x32x16_bf16 v[80:95], v[160:163], v[28:31], v[80:95]
    ds_read_b128 v[168:171], v5 offset:21504
    v_cvt_pk_bf16_f32 v96, v64, v65
    v_exp_f32 v68, v68
    v_exp_f32 v69, v69
    v_cvt_pk_bf16_f32 v97, v66, v67
    v_exp_f32 v70, v70
    v_mfma_f32_32x32x16_bf16 v[128:143], v[180:183], v[104:107], v[128:143]
    ds_read_b128 v[172:175], v5 offset:18432
    v_exp_f32 v71, v71
    v_cvt_pk_bf16_f32 v98, v68, v69
    v_exp_f32 v72, v72
    v_exp_f32 v73, v73
    v_cvt_pk_bf16_f32 v99, v70, v71
    v_mfma_f32_32x32x16_bf16 v[128:143], v[184:187], v[108:111], v[128:143]
    ds_read_b128 v[176:179], v5 offset:19456
    v_exp_f32 v74, v74
    v_exp_f32 v75, v75
    v_cvt_pk_bf16_f32 v100, v72, v73
    v_exp_f32 v76, v76
    v_exp_f32 v77, v77
    v_smfmac_f32_16x16x64_bf16 v[148:151], v[152:155], v[104:111], v200
    ds_read_b32 v202, v255 offset:48
    v_cvt_pk_bf16_f32 v101, v74, v75
    v_exp_f32 v78, v78
    v_exp_f32 v79, v79
    v_cvt_pk_bf16_f32 v102, v76, v77
    v_cvt_pk_bf16_f32 v103, v78, v79
    s_waitcnt lgkmcnt(0)
    v_mfma_f32_32x32x16_bf16 v[64:79], v[164:167], v[16:19], v[32:47]
    v_cmp_gt_u32 vcc, v201, v202
    v_exp_f32 v80, v80
    v_exp_f32 v81, v81
    v_exp_f32 v82, v82
    v_exp_f32 v83, v83
    v_mfma_f32_32x32x16_bf16 v[64:79], v[168:171], v[20:23], v[64:79]
    s_cbranch_vccnz LA_sp2
LA_spr2:
    v_cvt_pk_bf16_f32 v104, v80, v81
    v_exp_f32 v84, v84
    v_exp_f32 v85, v85
    v_cvt_pk_bf16_f32 v105, v82, v83
    v_exp_f32 v86, v86
    v_mfma_f32_32x32x16_bf16 v[112:127], v[172:175], v[96:99], v[112:127]
    s_add_u32 m0, s51, 8192
    v_exp_f32 v87, v87
    v_cvt_pk_bf16_f32 v106, v84, v85
    v_exp_f32 v88, v88
    v_exp_f32 v89, v89
    v_cvt_pk_bf16_f32 v107, v86, v87
    v_mfma_f32_32x32x16_bf16 v[112:127], v[176:179], v[100:103], v[112:127]
    buffer_load_dwordx4 v5, s[12:15], s50 offen sc1 lds
    v_exp_f32 v90, v90
    v_exp_f32 v91, v91
    v_cvt_pk_bf16_f32 v108, v88, v89
    v_exp_f32 v92, v92
    v_exp_f32 v93, v93
    v_smfmac_f32_16x16x64_bf16 v[144:147], v[152:155], v[96:103], v200
    buffer_load_dwordx4 v5, s[12:15], s50 offen offset:1024 sc1 lds
    s_add_u32 s50, s50, 0x2000
    v_cvt_pk_bf16_f32 v109, v90, v91
    v_exp_f32 v94, v94
    v_exp_f32 v95, v95
    v_cvt_pk_bf16_f32 v110, v92, v93
    v_cvt_pk_bf16_f32 v111, v94, v95
    v_mfma_f32_32x32x16_bf16 v[80:95], v[164:167], v[24:27], v[48:63]
    ds_read_b128 v[156:159], v5 offset:24576
    v_exp_f32 v64, v64
    v_exp_f32 v65, v65
    v_exp_f32 v66, v66
    v_exp_f32 v67, v67
    v_mfma_f32_32x32x16_bf16 v[80:95], v[168:171], v[28:31], v[80:95]
    ds_read_b128 v[160:163], v5 offset:25600
    v_cvt_pk_bf16_f32 v96, v64, v65
    v_exp_f32 v68, v68
    v_exp_f32 v69, v69
    v_cvt_pk_bf16_f32 v97, v66, v67
    v_exp_f32 v70, v70
    v_mfma_f32_32x32x16_bf16 v[128:143], v[172:175], v[104:107], v[128:143]
    ds_read_b128 v[180:183], v5 offset:22528
    v_exp_f32 v71, v71
    v_cvt_pk_bf16_f32 v98, v68, v69
    v_exp_f32 v72, v72
    v_exp_f32 v73, v73
    v_cvt_pk_bf16_f32 v99, v70, v71
    v_mfma_f32_32x32x16_bf16 v[128:143], v[176:179], v[108:111], v[128:143]
    ds_read_b128 v[184:187], v5 offset:23552
    v_exp_f32 v74, v74
    v_exp_f32 v75, v75
    v_cvt_pk_bf16_f32 v100, v72, v73
    v_exp_f32 v76, v76
    v_exp_f32 v77, v77
    v_smfmac_f32_16x16x64_bf16 v[148:151], v[152:155], v[104:111], v200
    v_cvt_pk_bf16_f32 v101, v74, v75
    v_exp_f32 v78, v78
    v_exp_f32 v79, v79
    v_cvt_pk_bf16_f32 v102, v76, v77
    v_cvt_pk_bf16_f32 v103, v78, v79
    s_waitcnt lgkmcnt(0)
    v_mfma_f32_32x32x16_bf16 v[64:79], v[156:159], v[16:19], v[32:47]
    v_add_u32 v201, 1, v201
    v_exp_f32 v80, v80
    v_exp_f32 v81, v81
    v_exp_f32 v82, v82
    v_exp_f32 v83, v83
    v_mfma_f32_32x32x16_bf16 v[64:79], v[160:163], v[20:23], v[64:79]
    s_waitcnt vmcnt(2)
    ds_write_b32 v254, v201 offset:48
    v_cvt_pk_bf16_f32 v104, v80, v81
    v_exp_f32 v84, v84
    v_exp_f32 v85, v85
    v_cvt_pk_bf16_f32 v105, v82, v83
    v_exp_f32 v86, v86
    v_mfma_f32_32x32x16_bf16 v[112:127], v[180:183], v[96:99], v[112:127]
    v_exp_f32 v87, v87
    v_cvt_pk_bf16_f32 v106, v84, v85
    v_exp_f32 v88, v88
    v_exp_f32 v89, v89
    v_cvt_pk_bf16_f32 v107, v86, v87
    v_mfma_f32_32x32x16_bf16 v[112:127], v[184:187], v[100:103], v[112:127]
    v_exp_f32 v90, v90
    v_exp_f32 v91, v91
    v_cvt_pk_bf16_f32 v108, v88, v89
    v_exp_f32 v92, v92
    v_exp_f32 v93, v93
    v_smfmac_f32_16x16x64_bf16 v[144:147], v[152:155], v[96:103], v200
    v_cvt_pk_bf16_f32 v109, v90, v91
    v_exp_f32 v94, v94
    v_exp_f32 v95, v95
    v_cvt_pk_bf16_f32 v110, v92, v93
    v_cvt_pk_bf16_f32 v111, v94, v95
    v_mfma_f32_32x32x16_bf16 v[80:95], v[156:159], v[24:27], v[48:63]
    ds_read_b128 v[164:167], v5 offset:28672
    v_exp_f32 v64, v64
    v_exp_f32 v65, v65
    v_exp_f32 v66, v66
    v_exp_f32 v67, v67
    v_mfma_f32_32x32x16_bf16 v[80:95], v[160:163], v[28:31], v[80:95]
    ds_read_b128 v[168:171], v5 offset:29696
    v_cvt_pk_bf16_f32 v96, v64, v65
    v_exp_f32 v68, v68
    v_exp_f32 v69, v69
    v_cvt_pk_bf16_f32 v97, v66, v67
    v_exp_f32 v70, v70
    v_mfma_f32_32x32x16_bf16 v[128:143], v[180:183], v[104:107], v[128:143]
    ds_read_b128 v[172:175], v5 offset:26624
    v_exp_f32 v71, v71
    v_cvt_pk_bf16_f32 v98, v68, v69
    v_exp_f32 v72, v72
    v_exp_f32 v73, v73
    v_cvt_pk_bf16_f32 v99, v70, v71
    v_mfma_f32_32x32x16_bf16 v[128:143], v[184:187], v[108:111], v[128:143]
    ds_read_b128 v[176:179], v5 offset:27648
    v_exp_f32 v74, v74
    v_exp_f32 v75, v75
    v_cvt_pk_bf16_f32 v100, v72, v73
    v_exp_f32 v76, v76
    v_exp_f32 v77, v77
    v_smfmac_f32_16x16x64_bf16 v[148:151], v[152:155], v[104:111], v200
    ds_read_b32 v202, v255 offset:48
    v_cvt_pk_bf16_f32 v101, v74, v75
    v_exp_f32 v78, v78
    v_exp_f32 v79, v79
    v_cvt_pk_bf16_f32 v102, v76, v77
    v_cvt_pk_bf16_f32 v103, v78, v79
    s_waitcnt lgkmcnt(0)
    v_mfma_f32_32x32x16_bf16 v[64:79], v[164:167], v[16:19], v[32:47]
    v_cmp_gt_u32 vcc, v201, v202
    v_exp_f32 v80, v80
    v_exp_f32 v81, v81
    v_exp_f32 v82, v82
    v_exp_f32 v83, v83
    v_mfma_f32_32x32x16_bf16 v[64:79], v[168:171], v[20:23], v[64:79]
    s_cbranch_vccnz LA_sp3
LA_spr3:
    v_cvt_pk_bf16_f32 v104, v80, v81
    v_exp_f32 v84, v84
    v_exp_f32 v85, v85
    v_cvt_pk_bf16_f32 v105, v82, v83
    v_exp_f32 v86, v86
    v_mfma_f32_32x32x16_bf16 v[112:127], v[172:175], v[96:99], v[112:127]
    s_add_u32 m0, s51, 16384
    v_exp_f32 v87, v87
    v_cvt_pk_bf16_f32 v106, v84, v85
    v_exp_f32 v88, v88
    v_exp_f32 v89, v89
    v_cvt_pk_bf16_f32 v107, v86, v87
    v_mfma_f32_32x32x16_bf16 v[112:127], v[176:179], v[100:103], v[112:127]
    buffer_load_dwordx4 v5, s[12:15], s50 offen sc1 lds
    v_exp_f32 v90, v90
    v_exp_f32 v91, v91
    v_cvt_pk_bf16_f32 v108, v88, v89
    v_exp_f32 v92, v92
    v_exp_f32 v93, v93
    v_smfmac_f32_16x16x64_bf16 v[144:147], v[152:155], v[96:103], v200
    buffer_load_dwordx4 v5, s[12:15], s50 offen offset:1024 sc1 lds
    s_add_u32 s50, s50, 0x2000
    v_cvt_pk_bf16_f32 v109, v90, v91
    v_exp_f32 v94, v94
    v_exp_f32 v95, v95
    v_cvt_pk_bf16_f32 v110, v92, v93
    v_cvt_pk_bf16_f32 v111, v94, v95
    v_mfma_f32_32x32x16_bf16 v[80:95], v[164:167], v[24:27], v[48:63]
    ds_read_b128 v[156:159], v5 offset:0
    v_exp_f32 v64, v64
    v_exp_f32 v65, v65
    v_exp_f32 v66, v66
    v_exp_f32 v67, v67
    v_mfma_f32_32x32x16_bf16 v[80:95], v[168:171], v[28:31], v[80:95]
    ds_read_b128 v[160:163], v5 offset:1024
    v_cvt_pk_bf16_f32 v96, v64, v65
    v_exp_f32 v68, v68
    v_exp_f32 v69, v69
    v_cvt_pk_bf16_f32 v97, v66, v67
    v_exp_f32 v70, v70
    v_mfma_f32_32x32x16_bf16 v[128:143], v[172:175], v[104:107], v[128:143]
    ds_read_b128 v[180:183], v5 offset:30720
    v_exp_f32 v71, v71
    v_cvt_pk_bf16_f32 v98, v68, v69
    v_exp_f32 v72, v72
    v_exp_f32 v73, v73
    v_cvt_pk_bf16_f32 v99, v70, v71
    v_mfma_f32_32x32x16_bf16 v[128:143], v[176:179], v[108:111], v[128:143]
    ds_read_b128 v[184:187], v5 offset:31744
    v_exp_f32 v74, v74
    v_exp_f32 v75, v75
    v_cvt_pk_bf16_f32 v100, v72, v73
    v_exp_f32 v76, v76
    v_exp_f32 v77, v77
    v_smfmac_f32_16x16x64_bf16 v[148:151], v[152:155], v[104:111], v200
    v_cvt_pk_bf16_f32 v101, v74, v75
    v_exp_f32 v78, v78
    v_exp_f32 v79, v79
    v_cvt_pk_bf16_f32 v102, v76, v77
    v_cvt_pk_bf16_f32 v103, v78, v79
    s_waitcnt lgkmcnt(0)
    v_mfma_f32_32x32x16_bf16 v[64:79], v[156:159], v[16:19], v[32:47]
    v_add_u32 v201, 1, v201
    v_exp_f32 v80, v80
    v_exp_f32 v81, v81
    v_exp_f32 v82, v82
    v_exp_f32 v83, v83
    v_mfma_f32_32x32x16_bf16 v[64:79], v[160:163], v[20:23], v[64:79]
    s_waitcnt vmcnt(2)
    ds_write_b32 v254, v201 offset:48
    v_cvt_pk_bf16_f32 v104, v80, v81
    v_exp_f32 v84, v84
    v_exp_f32 v85, v85
    v_cvt_pk_bf16_f32 v105, v82, v83
    v_exp_f32 v86, v86
    v_mfma_f32_32x32x16_bf16 v[112:127], v[180:183], v[96:99], v[112:127]
    v_exp_f32 v87, v87
    v_cvt_pk_bf16_f32 v106, v84, v85
    v_exp_f32 v88, v88
    v_exp_f32 v89, v89
    v_cvt_pk_bf16_f32 v107, v86, v87
    v_mfma_f32_32x32x16_bf16 v[112:127], v[184:187], v[100:103], v[112:127]
    v_exp_f32 v90, v90
    v_exp_f32 v91, v91
    v_cvt_pk_bf16_f32 v108, v88, v89
    v_exp_f32 v92, v92
    v_exp_f32 v93, v93
    v_smfmac_f32_16x16x64_bf16 v[144:147], v[152:155], v[96:103], v200
    s_add_u32 s59, s59, 1
    s_cmp_lt_u32 s59, 8
    v_cvt_pk_bf16_f32 v109, v90, v91
    v_exp_f32 v94, v94
    v_exp_f32 v95, v95
    v_cvt_pk_bf16_f32 v110, v92, v93
    v_cvt_pk_bf16_f32 v111, v94, v95
    s_cbranch_scc1 LA_loop
    v_mfma_f32_32x32x16_bf16 v[128:143], v[180:183], v[104:107], v[128:143]
    v_mfma_f32_32x32x16_bf16 v[128:143], v[184:187], v[108:111], v[128:143]
    v_smfmac_f32_16x16x64_bf16 v[148:151], v[152:155], v[104:111], v200
    s_mov_b32 s60, 0
LA_fin:
    s_nop 15
    v_add_f32 v144, v144, v145
    v_add_f32 v148, v148, v149
    s_mov_b32 s61, 0x53800000
    v_cmp_gt_f32 vcc, s61, v144
    v_cmp_gt_f32 s[62:63], s61, v148
    s_nop 0
    s_and_b64 vcc, vcc, s[62:63]
    s_cmp_eq_u64 vcc, -1
    s_cbranch_scc1 LA_store
    s_cmp_eq_u32 s60, 0
    s_cbranch_scc1 LA_slow
LA_store:
    v_rcp_f32 v188, v144
    v_rcp_f32 v189, v144
    v_rcp_f32 v190, v148
    v_rcp_f32 v191, v148
    v_mul_f32 v112, v112, v188
    v_mul_f32 v113, v113, v188
    v_mul_f32 v114, v114, v188
    v_mul_f32 v115, v115, v188
    v_mul_f32 v116, v116, v188
    v_mul_f32 v117, v117, v188
    v_mul_f32 v118, v118, v188
    v_mul_f32 v119, v119, v188
    v_mul_f32 v120, v120, v188
    v_mul_f32 v121, v121, v188
    v_mul_f32 v122, v122, v188
    v_mul_f32 v123, v123, v188
    v_mul_f32 v124, v124, v188
    v_mul_f32 v125, v125, v188
    v_mul_f32 v126, v126, v188
    v_mul_f32 v127, v127, v188
    v_cvt_pk_bf16_f32 v96, v112, v113
    v_cvt_pk_bf16_f32 v97, v114, v115
    v_cvt_pk_bf16_f32 v98, v120, v121
    v_cvt_pk_bf16_f32 v99, v122, v123
    buffer_store_dwordx4 v[96:99], v7, s[24:27], s47 offen offset:0 sc1
    v_cvt_pk_bf16_f32 v100, v116, v117
    v_cvt_pk_bf16_f32 v101, v118, v119
    v_cvt_pk_bf16_f32 v102, v124, v125
    v_cvt_pk_bf16_f32 v103, v126, v127
    buffer_store_dwordx4 v[100:103], v7, s[24:27], s47 offen offset:512 sc1
    v_mul_f32 v128, v128, v190
    v_mul_f32 v129, v129, v190
    v_mul_f32 v130, v130, v190
    v_mul_f32 v131, v131, v190
    v_mul_f32 v132, v132, v190
    v_mul_f32 v133, v133, v190
    v_mul_f32 v134, v134, v190
    v_mul_f32 v135, v135, v190
    v_mul_f32 v136, v136, v190
    v_mul_f32 v137, v137, v190
    v_mul_f32 v138, v138, v190
    v_mul_f32 v139, v139, v190
    v_mul_f32 v140, v140, v190
    v_mul_f32 v141, v141, v190
    v_mul_f32 v142, v142, v190
    v_mul_f32 v143, v143, v190
    v_cvt_pk_bf16_f32 v104, v128, v129
    v_cvt_pk_bf16_f32 v105, v130, v131
    v_cvt_pk_bf16_f32 v106, v136, v137
    v_cvt_pk_bf16_f32 v107, v138, v139
    buffer_store_dwordx4 v[104:107], v7, s[24:27], s47 offen offset:1024 sc1
    v_cvt_pk_bf16_f32 v108, v132, v133
    v_cvt_pk_bf16_f32 v109, v134, v135
    v_cvt_pk_bf16_f32 v110, v140, v141
    v_cvt_pk_bf16_f32 v111, v142, v143
    buffer_store_dwordx4 v[108:111], v7, s[24:27], s47 offen offset:1536 sc1
    v_mov_b32 v8, 1
    v_mov_b32 v9, 0
    s_waitcnt vmcnt(0)
    s_mov_b64 exec, 1
    buffer_store_dword v8, v9, s[24:27], s53 offen sc1
    s_mov_b64 exec, -1
    v_lshrrev_b32 v10, 5, v1
    v_lshlrev_b32 v11, 1, v10
    v_and_b32 v14, 3, v1
    v_xor_b32 v11, v11, v14
    v_lshlrev_b32 v11, 4, v11
    v_bfe_u32 v14, v1, 4, 1
    v_lshl_add_u32 v11, v14, 6, v11
    v_bfe_u32 v14, v1, 2, 2
    v_lshl_add_u32 v10, v10, 2, v14
    v_lshl_add_u32 v10, v10, 11, v11
    s_lshr_b32 s48, s2, 5
    s_lshl_b32 s48, s48, 8
    s_bfe_u32 s49, s2, 0x10002
    s_lshl_b32 s49, s49, 7
    s_add_u32 s48, s48, s49
    s_lshl_b32 s49, s40, 17
    s_add_u32 s48, s48, s49
    s_lshl_b32 s49, s40, 13
    v_add_u32 v201, 1, v201
    ds_write_b32 v254, v201 offset:48
    s_mov_b32 s3, 0
LA_w6:
    ds_read_b32 v13, v255 offset:48
    s_add_u32 s3, s3, 1
    s_waitcnt lgkmcnt(0)
    v_cmp_gt_u32 vcc, v201, v13
    s_nop 4
    s_cbranch_vccz LA_w6_ok
    s_sleep 1
    s_cmp_lt_u32 s3, 8000000
    s_cbranch_scc1 LA_w6
LA_w6_ok:
    s_add_u32 m0, s49, 0
    s_add_u32 s50, s48, 1048576
    buffer_load_dwordx4 v10, s[20:23], s50 offen lds
    s_add_u32 m0, s49, 1024
    s_add_u32 s50, s48, 1064960
    buffer_load_dwordx4 v10, s[20:23], s50 offen lds
    s_add_u32 m0, s49, 2048
    s_add_u32 s50, s48, 1081344
    buffer_load_dwordx4 v10, s[20:23], s50 offen lds
    s_add_u32 m0, s49, 3072
    s_add_u32 s50, s48, 1097728
    buffer_load_dwordx4 v10, s[20:23], s50 offen lds
    s_add_u32 m0, s49, 4096
    s_add_u32 s50, s48, 1114112
    buffer_load_dwordx4 v10, s[20:23], s50 offen lds
    s_add_u32 m0, s49, 5120
    s_add_u32 s50, s48, 1130496
    buffer_load_dwordx4 v10, s[20:23], s50 offen lds
    s_add_u32 m0, s49, 6144
    s_add_u32 s50, s48, 1146880
    buffer_load_dwordx4 v10, s[20:23], s50 offen lds
    s_add_u32 m0, s49, 7168
    s_add_u32 s50, s48, 1163264
    buffer_load_dwordx4 v10, s[20:23], s50 offen lds
    s_waitcnt vmcnt(0)
L_end:
    s_endpgm
LA_slow:
    s_mov_b32 s60, 1
    v_mov_b32 v188, 0xff800000
    v_mov_b32 v189, 0xff800000
    s_mov_b32 s52, 0
LA_s1:
    buffer_load_dwordx4 v[156:159], v5, s[12:15], s52 offen offset:0 sc1
    buffer_load_dwordx4 v[160:163], v5, s[12:15], s52 offen offset:1024 sc1
    s_waitcnt vmcnt(0)
    v_mfma_f32_32x32x16_bf16 v[64:79], v[156:159], v[16:19], 0
    v_mfma_f32_32x32x16_bf16 v[64:79], v[160:163], v[20:23], v[64:79]
    v_mfma_f32_32x32x16_bf16 v[80:95], v[156:159], v[24:27], 0
    v_mfma_f32_32x32x16_bf16 v[80:95], v[160:163], v[28:31], v[80:95]
    s_nop 15
    v_max3_f32 v188, v188, v64, v65
    v_max3_f32 v188, v188, v66, v67
    v_max3_f32 v188, v188, v68, v69
    v_max3_f32 v188, v188, v70, v71
    v_max3_f32 v188, v188, v72, v73
    v_max3_f32 v188, v188, v74, v75
    v_max3_f32 v188, v188, v76, v77
    v_max3_f32 v188, v188, v78, v79
    v_max3_f32 v189, v189, v80, v81
    v_max3_f32 v189, v189, v82, v83
    v_max3_f32 v189, v189, v84, v85
    v_max3_f32 v189, v189, v86, v87
    v_max3_f32 v189, v189, v88, v89
    v_max3_f32 v189, v189, v90, v91
    v_max3_f32 v189, v189, v92, v93
    v_max3_f32 v189, v189, v94, v95
    s_add_u32 s52, s52, 4096
    s_cmp_lt_u32 s52, 0x40000
    s_cbranch_scc1 LA_s1
    v_mov_b32 v196, v188
    s_nop 1
    v_permlane32_swap_b32 v188, v196
    v_max_f32 v188, v188, v196
    v_sub_f32 v32, 0, v188
    v_sub_f32 v33, 0, v188
    v_sub_f32 v34, 0, v188
    v_sub_f32 v35, 0, v188
    v_sub_f32 v36, 0, v188
    v_sub_f32 v37, 0, v188
    v_sub_f32 v38, 0, v188
    v_sub_f32 v39, 0, v188
    v_sub_f32 v40, 0, v188
    v_sub_f32 v41, 0, v188
    v_sub_f32 v42, 0, v188
    v_sub_f32 v43, 0, v188
    v_sub_f32 v44, 0, v188
    v_sub_f32 v45, 0, v188
    v_sub_f32 v46, 0, v188
    v_sub_f32 v47, 0, v188
    v_mov_b32 v112, 0
    v_mov_b32 v113, 0
    v_mov_b32 v114, 0
    v_mov_b32 v115, 0
    v_mov_b32 v116, 0
    v_mov_b32 v117, 0
    v_mov_b32 v118, 0
    v_mov_b32 v119, 0
    v_mov_b32 v120, 0
    v_mov_b32 v121, 0
    v_mov_b32 v122, 0
    v_mov_b32 v123, 0
    v_mov_b32 v124, 0
    v_mov_b32 v125, 0
    v_mov_b32 v126, 0
    v_mov_b32 v127, 0
    v_mov_b32 v144, 0
    v_mov_b32 v145, 0
    v_mov_b32 v146, 0
    v_mov_b32 v147, 0
    v_mov_b32 v196, v189
    s_nop 1
    v_permlane32_swap_b32 v189, v196
    v_max_f32 v189, v189, v196
    v_sub_f32 v48, 0, v189
    v_sub_f32 v49, 0, v189
    v_sub_f32 v50, 0, v189
    v_sub_f32 v51, 0, v189
    v_sub_f32 v52, 0, v189
    v_sub_f32 v53, 0, v189
    v_sub_f32 v54, 0, v189
    v_sub_f32 v55, 0, v189
    v_sub_f32 v56, 0, v189
    v_sub_f32 v57, 0, v189
    v_sub_f32 v58, 0, v189
    v_sub_f32 v59, 0, v189
    v_sub_f32 v60, 0, v189
    v_sub_f32 v61, 0, v189
    v_sub_f32 v62, 0, v189
    v_sub_f32 v63, 0, v189
    v_mov_b32 v128, 0
    v_mov_b32 v129, 0
    v_mov_b32 v130, 0
    v_mov_b32 v131, 0
    v_mov_b32 v132, 0
    v_mov_b32 v133, 0
    v_mov_b32 v134, 0
    v_mov_b32 v135, 0
    v_mov_b32 v136, 0
    v_mov_b32 v137, 0
    v_mov_b32 v138, 0
    v_mov_b32 v139, 0
    v_mov_b32 v140, 0
    v_mov_b32 v141, 0
    v_mov_b32 v142, 0
    v_mov_b32 v143, 0
    v_mov_b32 v148, 0
    v_mov_b32 v149, 0
    v_mov_b32 v150, 0
    v_mov_b32 v151, 0
    s_mov_b32 s52, 0
LA_s2:
    buffer_load_dwordx4 v[156:159], v5, s[12:15], s52 offen offset:0 sc1
    buffer_load_dwordx4 v[160:163], v5, s[12:15], s52 offen offset:1024 sc1
    buffer_load_dwordx4 v[172:175], v5, s[12:15], s52 offen offset:2048 sc1
    buffer_load_dwordx4 v[176:179], v5, s[12:15], s52 offen offset:3072 sc1
    s_waitcnt vmcnt(0)
    v_mfma_f32_32x32x16_bf16 v[64:79], v[156:159], v[16:19], v[32:47]
    v_mfma_f32_32x32x16_bf16 v[64:79], v[160:163], v[20:23], v[64:79]
    v_mfma_f32_32x32x16_bf16 v[80:95], v[156:159], v[24:27], v[48:63]
    v_mfma_f32_32x32x16_bf16 v[80:95], v[160:163], v[28:31], v[80:95]
    s_nop 15
    v_exp_f32 v64, v64
    v_exp_f32 v65, v65
    v_exp_f32 v66, v66
    v_exp_f32 v67, v67
    v_cvt_pk_bf16_f32 v96, v64, v65
    v_exp_f32 v68, v68
    v_exp_f32 v69, v69
    v_cvt_pk_bf16_f32 v97, v66, v67
    v_exp_f32 v70, v70
    v_exp_f32 v71, v71
    v_cvt_pk_bf16_f32 v98, v68, v69
    v_exp_f32 v72, v72
    v_exp_f32 v73, v73
    v_cvt_pk_bf16_f32 v99, v70, v71
    v_exp_f32 v74, v74
    v_exp_f32 v75, v75
    v_cvt_pk_bf16_f32 v100, v72, v73
    v_exp_f32 v76, v76
    v_exp_f32 v77, v77
    v_cvt_pk_bf16_f32 v101, v74, v75
    v_exp_f32 v78, v78
    v_exp_f32 v79, v79
    v_cvt_pk_bf16_f32 v102, v76, v77
    v_cvt_pk_bf16_f32 v103, v78, v79
    v_exp_f32 v80, v80
    v_exp_f32 v81, v81
    v_exp_f32 v82, v82
    v_exp_f32 v83, v83
    v_cvt_pk_bf16_f32 v104, v80, v81
    v_exp_f32 v84, v84
    v_exp_f32 v85, v85
    v_cvt_pk_bf16_f32 v105, v82, v83
    v_exp_f32 v86, v86
    v_exp_f32 v87, v87
    v_cvt_pk_bf16_f32 v106, v84, v85
    v_exp_f32 v88, v88
    v_exp_f32 v89, v89
    v_cvt_pk_bf16_f32 v107, v86, v87
    v_exp_f32 v90, v90
    v_exp_f32 v91, v91
    v_cvt_pk_bf16_f32 v108, v88, v89
    v_exp_f32 v92, v92
    v_exp_f32 v93, v93
    v_cvt_pk_bf16_f32 v109, v90, v91
    v_exp_f32 v94, v94
    v_exp_f32 v95, v95
    v_cvt_pk_bf16_f32 v110, v92, v93
    v_cvt_pk_bf16_f32 v111, v94, v95
    s_nop 3
    v_mfma_f32_32x32x16_bf16 v[112:127], v[172:175], v[96:99], v[112:127]
    v_mfma_f32_32x32x16_bf16 v[112:127], v[176:179], v[100:103], v[112:127]
    v_smfmac_f32_16x16x64_bf16 v[144:147], v[152:155], v[96:103], v200
    v_mfma_f32_32x32x16_bf16 v[128:143], v[172:175], v[104:107], v[128:143]
    v_mfma_f32_32x32x16_bf16 v[128:143], v[176:179], v[108:111], v[128:143]
    v_smfmac_f32_16x16x64_bf16 v[148:151], v[152:155], v[104:111], v200
    s_nop 15
    s_add_u32 s52, s52, 4096
    s_cmp_lt_u32 s52, 0x40000
    s_cbranch_scc1 LA_s2
    s_branch LA_fin
LA_cs:
    v_add_u32 v220, s58, v222
    v_add_u32 v221, s58, v223
    ds_read_b128 v[128:131], v220 offset:0
    ds_read_b128 v[132:135], v220 offset:1024
    ds_read_b128 v[136:139], v220 offset:2048
    ds_read_b128 v[140:143], v220 offset:3072
    ds_read_b128 v[144:147], v220 offset:16384
    ds_read_b128 v[148:151], v220 offset:17408
    ds_read_b128 v[152:155], v220 offset:18432
    ds_read_b128 v[156:159], v220 offset:19456
    ds_read_b128 v[160:163], v221 offset:0
    ds_read_b128 v[164:167], v221 offset:1024
    ds_read_b128 v[168:171], v221 offset:2048
    ds_read_b128 v[172:175], v221 offset:3072
    s_add_u32 s47, s43, s46
    s_lshl_b32 s48, s42, 4
    s_add_u32 s47, s47, s48
    s_lshl_b32 s47, s47, 11
    s_lshl_b32 s48, s40, 7
    s_add_u32 s48, s48, s47
    v_lshlrev_b32 v220, 5, v3
    v_lshl_add_u32 v220, v4, 4, v220
    s_waitcnt lgkmcnt(0)
    v_mfma_f32_16x16x32_bf16 v[176:179], v[196:199], v[128:131], 0
    v_mfma_f32_16x16x32_bf16 v[180:183], v[196:199], v[144:147], 0
    v_mfma_f32_16x16x32_bf16 v[184:187], v[196:199], v[160:163], 0
    v_mfma_f32_16x16x32_bf16 v[176:179], v[196:199], v[132:135], v[176:179]
    v_mfma_f32_16x16x32_bf16 v[180:183], v[196:199], v[148:151], v[180:183]
    v_mfma_f32_16x16x32_bf16 v[184:187], v[196:199], v[164:167], v[184:187]
    v_mfma_f32_16x16x32_bf16 v[176:179], v[196:199], v[136:139], v[176:179]
    v_mfma_f32_16x16x32_bf16 v[180:183], v[196:199], v[152:155], v[180:183]
    v_mfma_f32_16x16x32_bf16 v[184:187], v[196:199], v[168:171], v[184:187]
    v_mfma_f32_16x16x32_bf16 v[176:179], v[196:199], v[140:143], v[176:179]
    v_mfma_f32_16x16x32_bf16 v[180:183], v[196:199], v[156:159], v[180:183]
    v_mfma_f32_16x16x32_bf16 v[184:187], v[196:199], v[172:175], v[184:187]
    s_nop 5
    v_add_f32_dpp v176, v176, v176 row_ror:4 row_mask:0xf bank_mask:0xf
    v_add_f32_dpp v177, v177, v177 row_ror:4 row_mask:0xf bank_mask:0xf
    v_add_f32_dpp v178, v178, v178 row_ror:4 row_mask:0xf bank_mask:0xf
    v_add_f32_dpp v179, v179, v179 row_ror:4 row_mask:0xf bank_mask:0xf
    v_add_f32_dpp v180, v180, v180 row_ror:4 row_mask:0xf bank_mask:0xf
    v_add_f32_dpp v181, v181, v181 row_ror:4 row_mask:0xf bank_mask:0xf
    v_add_f32_dpp v182, v182, v182 row_ror:4 row_mask:0xf bank_mask:0xf
    v_add_f32_dpp v183, v183, v183 row_ror:4 row_mask:0xf bank_mask:0xf
    v_add_f32_dpp v184, v184, v184 row_ror:4 row_mask:0xf bank_mask:0xf
    v_add_f32_dpp v185, v185, v185 row_ror:4 row_mask:0xf bank_mask:0xf
    v_add_f32_dpp v186, v186, v186 row_ror:4 row_mask:0xf bank_mask:0xf
    v_add_f32_dpp v187, v187, v187 row_ror:4 row_mask:0xf bank_mask:0xf
    v_add_f32_dpp v176, v176, v176 row_ror:8 row_mask:0xf bank_mask:0xf
    v_add_f32_dpp v177, v177, v177 row_ror:8 row_mask:0xf bank_mask:0xf
    v_add_f32_dpp v178, v178, v178 row_ror:8 row_mask:0xf bank_mask:0xf
    v_add_f32_dpp v179, v179, v179 row_ror:8 row_mask:0xf bank_mask:0xf
    v_add_f32_dpp v180, v180, v180 row_ror:8 row_mask:0xf bank_mask:0xf
    v_add_f32_dpp v181, v181, v181 row_ror:8 row_mask:0xf bank_mask:0xf
    v_add_f32_dpp v182, v182, v182 row_ror:8 row_mask:0xf bank_mask:0xf
    v_add_f32_dpp v183, v183, v183 row_ror:8 row_mask:0xf bank_mask:0xf
    v_add_f32_dpp v184, v184, v184 row_ror:8 row_mask:0xf bank_mask:0xf
    v_add_f32_dpp v185, v185, v185 row_ror:8 row_mask:0xf bank_mask:0xf
    v_add_f32_dpp v186, v186, v186 row_ror:8 row_mask:0xf bank_mask:0xf
    v_add_f32_dpp v187, v187, v187 row_ror:8 row_mask:0xf bank_mask:0xf
    s_mov_b32 exec_lo, 0x000f000f
    s_mov_b32 exec_hi, 0
    buffer_store_dwordx4 v[176:179], v220, s[24:27], s48 offen sc1
    buffer_store_dwordx4 v[180:183], v220, s[24:27], s48 offen offset:512 sc1
    buffer_store_dwordx4 v[184:187], v220, s[24:27], s47 offen offset:1024 sc1
    s_mov_b64 exec, -1
    s_setpc_b64 s[62:63]
LA_p1_s:
    s_mov_b32 s39, 0
LA_p1:
    buffer_load_dword v218, v216, s[28:31], 0 offen sc1
    s_add_u32 s39, s39, 1
    s_waitcnt vmcnt(0)
    v_cmp_ne_u32 vcc, 1, v218
    s_nop 4
    s_cbranch_vccz LA_p1_ok
    s_sleep 4
    s_cmp_lt_u32 s39, 1000000
    s_cbranch_scc1 LA_p1
LA_p1_ok:
    s_branch LA_p1_r
LA_p2_s:
    s_mov_b32 s39, 0
LA_p2:
    buffer_load_dword v218, v224, s[24:27], s64 offen sc1
    s_add_u32 s39, s39, 1
    s_waitcnt vmcnt(0)
    v_cmp_ne_u32 vcc, 1, v218
    s_nop 4
    s_cbranch_vccz LA_p2_ok
    s_sleep 4
    s_cmp_lt_u32 s39, 1000000
    s_cbranch_scc1 LA_p2
LA_p2_ok:
    s_branch LA_p2_r
LA_p4_s:
    s_mov_b32 s39, 0
LA_p4:
    buffer_load_dword v218, v224, s[24:27], s65 offen sc1
    s_add_u32 s39, s39, 1
    s_waitcnt vmcnt(0)
    v_cmp_ne_u32 vcc, 1, v218
    s_nop 4
    s_cbranch_vccz LA_p4_ok
    s_sleep 4
    s_cmp_lt_u32 s39, 1000000
    s_cbranch_scc1 LA_p4
LA_p4_ok:
    s_branch LA_p4_r
LA_sp0:
    s_mov_b32 s3, 0
LA_spw0:
    ds_read_b32 v202, v255 offset:48
    s_add_u32 s3, s3, 1
    s_waitcnt lgkmcnt(0)
    v_cmp_gt_u32 vcc, v201, v202
    s_nop 4
    s_cbranch_vccz LA_spw0_ok
    s_sleep 1
    s_cmp_lt_u32 s3, 8000000
    s_cbranch_scc1 LA_spw0
LA_spw0_ok:
    s_branch LA_spr0
LA_sp1:
    s_mov_b32 s3, 0
LA_spw1:
    ds_read_b32 v202, v255 offset:48
    s_add_u32 s3, s3, 1
    s_waitcnt lgkmcnt(0)
    v_cmp_gt_u32 vcc, v201, v202
    s_nop 4
    s_cbranch_vccz LA_spw1_ok
    s_sleep 1
    s_cmp_lt_u32 s3, 8000000
    s_cbranch_scc1 LA_spw1
LA_spw1_ok:
    s_branch LA_spr1
LA_sp2:
    s_mov_b32 s3, 0
LA_spw2:
    ds_read_b32 v202, v255 offset:48
    s_add_u32 s3, s3, 1
    s_waitcnt lgkmcnt(0)
    v_cmp_gt_u32 vcc, v201, v202
    s_nop 4
    s_cbranch_vccz LA_spw2_ok
    s_sleep 1
    s_cmp_lt_u32 s3, 8000000
    s_cbranch_scc1 LA_spw2
LA_spw2_ok:
    s_branch LA_spr2
LA_sp3:
    s_mov_b32 s3, 0
LA_spw3:
    ds_read_b32 v202, v255 offset:48
    s_add_u32 s3, s3, 1
    s_waitcnt lgkmcnt(0)
    v_cmp_gt_u32 vcc, v201, v202
    s_nop 4
    s_cbranch_vccz LA_spw3_ok
    s_sleep 1
    s_cmp_lt_u32 s3, 8000000
    s_cbranch_scc1 LA_spw3
LA_spw3_ok:
    s_branch LA_spr3
LA_xt:
    s_cmp_eq_u32 s40, 0
    s_cbranch_scc0 LA_xt1
    buffer_load_dword v13, v12, s[20:23], s55 offen
LA_xt1:
    s_cmp_eq_u32 s40, 1
    s_cbranch_scc0 LA_xtr
    global_load_dword v13, v[10:11], off
    s_branch LA_xtr
L_G:
    s_sub_u32 s40, s40, 4
    s_lshr_b32 s44, s40, 1
    s_and_b32 s45, s40, 1
    s_lshr_b32 s47, s2, 3
    s_lshl_b32 s48, s40, 3
    s_or_b32 s48, s48, s47
    s_cmp_lt_u32 s48, 5
    s_cbranch_scc0 LG_nt
    s_lshl_b32 s47, s47, 13
    s_getpc_b64 s[28:29]
Lpc_2:
    s_sub_u32 s28, s28, Lpc_2-parallel_sum__grouped_kv_mqa__mixer_channel_mlp__prompt_kernel
    s_subb_u32 s29, s29, 0
    v_lshlrev_b32 v20, 7, v1
    v_add_u32 v20, s47, v20
    v_min_u32 v20, Lcode_end-parallel_sum__grouped_kv_mqa__mixer_channel_mlp__prompt_kernel-4, v20
    v_mov_b32 v21, s29
    v_add_co_u32 v20, vcc, s28, v20
    s_nop 1
    v_addc_co_u32 v21, vcc, 0, v21, vcc
    global_load_dword v253, v[20:21], off
LG_nt:
    s_lshl_b32 s39, s40, 2
    s_add_u32 s39, s39, 160256
    v_mov_b32 v254, s39
    v_lshrrev_b32 v22, 4, v1
    v_mul_u32_u24 v22, 7168, v22
    v_min_u32 v23, 13, v3
    v_lshl_add_u32 v22, v23, 7, v22
    v_lshrrev_b32 v23, 2, v1
    v_and_b32 v24, 3, v1
    v_lshlrev_b32 v24, 7, v24
    v_lshl_add_u32 v23, v23, 11, v24
    s_lshr_b32 s47, s2, 3
    s_bfe_u32 s48, s2, 0x20001
    s_waitcnt lgkmcnt(0)
    s_cmp_eq_u32 s40, 3
    s_cbranch_scc1 LG_eq
    s_mov_b32 s20, s8
    s_and_b32 s21, s9, 0xffff
    s_mov_b32 s22, 0x700000
    s_mov_b32 s23, 0x20000
    s_mul_i32 s49, s47, 28672
    s_mul_i32 s50, s48, 1792
    s_add_u32 s49, s49, s50
    s_and_b32 s50, s2, 1
    s_lshl_b32 s50, s50, 2
    s_add_u32 s50, s50, s40
    s_mul_i32 s50, s50, 917504
    s_add_u32 s49, s49, s50
    s_branch LG_ed
LG_eq:
    s_mov_b32 s20, s66
    s_and_b32 s21, s67, 0xffff
    s_mov_b32 s22, 0x200000
    s_mov_b32 s23, 0x20000
    s_lshl_b32 s49, s47, 15
    s_lshl_b32 s50, s48, 9
    s_add_u32 s49, s49, s50
    s_and_b32 s50, s2, 1
    s_lshl_b32 s50, s50, 20
    s_add_u32 s49, s49, s50
LG_ed:
    v_and_b32 v11, 7, v3
    v_xor_b32 v11, v11, v4
    v_lshlrev_b32 v11, 4, v11
    v_lshl_add_u32 v11, v3, 7, v11
    s_lshl_b32 s47, s44, 13
    v_add_u32 v11, s47, v11
    v_xor_b32 v10, 64, v11
    v_lshlrev_b32 v15, 9, v4
    v_bfe_u32 v13, v1, 2, 2
    v_lshl_add_u32 v15, v13, 6, v15
    v_and_b32 v13, 3, v1
    v_lshl_add_u32 v15, v13, 3, v15
    v_and_b32 v13, 1, v4
    v_lshl_add_u32 v15, v13, 5, v15
    s_lshl_b32 s47, s45, 5
    v_xor_b32 v14, s47, v15
    v_add_u32 v14, 49152, v14
    s_lshl_b32 s47, s45, 14
    s_add_u32 s47, s47, 16384
    v_add_u32 v12, s47, v15
    v_xor_b32 v13, 32, v12
    s_mov_b32 s24, s6
    s_and_b32 s25, s7, 0xffff
    s_mov_b32 s26, 0x10000000
    s_mov_b32 s27, 0x20000
    s_mov_b32 s28, s62
    s_and_b32 s29, s63, 0xffff
    s_mov_b32 s30, 0x100
    s_mov_b32 s31, 0x20000
    v_mov_b32 v6, 0
    v_mov_b32 v7, 1
    s_cmp_eq_u32 s42, 7
    s_cbranch_scc0 LG_nz
    v_mov_b64 v[16:17], 0
    v_mov_b64 v[18:19], 0
    s_lshl_b32 s37, s41, 2
    s_add_u32 s37, s37, s40
    s_lshl_b32 s38, s37, 10
    s_add_u32 s38, s38, 0x2e00000
    buffer_store_dwordx4 v[16:19], v5, s[24:27], s38 offen sc1
    s_lshl_b32 s37, s37, 2
    s_waitcnt vmcnt(0)
    s_mov_b64 exec, 1
    buffer_store_dword v7, v6, s[28:31], s37 offen sc1
    s_mov_b64 exec, -1
LG_nz:
    s_mov_b32 s58, 0
    s_mov_b32 s60, 53248
    s_mov_b32 s61, 53248
    s_mov_b32 s59, 0
    s_barrier
    ds_read_b128 v[160:163], v11 offset:0
    ds_read_b128 v[164:167], v11 offset:2048
    ds_read_b128 v[168:171], v11 offset:4096
    ds_read_b128 v[172:175], v11 offset:6144
    ds_read_b64_tr_b16 v[192:193], v12 offset:0
    ds_read_b64_tr_b16 v[194:195], v12 offset:256
    ds_read_b64_tr_b16 v[196:197], v13 offset:0
    ds_read_b64_tr_b16 v[198:199], v13 offset:256
    ds_read_b64_tr_b16 v[200:201], v12 offset:4096
    ds_read_b64_tr_b16 v[202:203], v12 offset:4352
    ds_read_b64_tr_b16 v[204:205], v13 offset:4096
    ds_read_b64_tr_b16 v[206:207], v13 offset:4352
    ds_read_b64_tr_b16 v[208:209], v12 offset:8192
    ds_read_b64_tr_b16 v[210:211], v12 offset:8448
    ds_read_b64_tr_b16 v[212:213], v13 offset:8192
    ds_read_b64_tr_b16 v[214:215], v13 offset:8448
    ds_read_b64_tr_b16 v[216:217], v12 offset:12288
    ds_read_b64_tr_b16 v[218:219], v12 offset:12544
    ds_read_b64_tr_b16 v[220:221], v13 offset:12288
    ds_read_b64_tr_b16 v[222:223], v13 offset:12544
    ds_read_b64_tr_b16 v[224:225], v14 offset:0
    ds_read_b64_tr_b16 v[226:227], v14 offset:256
    s_waitcnt lgkmcnt(0)
    v_mfma_f32_16x16x32_bf16 v[16:19], v[192:195], v[160:163], 0
    ds_read_b128 v[176:179], v10 offset:0
    ds_read_b128 v[180:183], v10 offset:2048
    v_mfma_f32_16x16x32_bf16 v[52:55], v[192:195], v[164:167], 0
    ds_read_b128 v[184:187], v10 offset:4096
    ds_read_b128 v[188:191], v10 offset:6144
    v_mfma_f32_16x16x32_bf16 v[88:91], v[192:195], v[168:171], 0
    ds_read_b64_tr_b16 v[228:229], v12 offset:2048
    ds_read_b64_tr_b16 v[230:231], v12 offset:2304
    v_mfma_f32_16x16x32_bf16 v[124:127], v[192:195], v[172:175], 0
    ds_read_b64_tr_b16 v[232:233], v13 offset:2048
    ds_read_b64_tr_b16 v[234:235], v13 offset:2304
    v_mfma_f32_16x16x32_bf16 v[20:23], v[196:199], v[160:163], 0
    ds_read_b64_tr_b16 v[236:237], v12 offset:6144
    ds_read_b64_tr_b16 v[238:239], v12 offset:6400
    v_mfma_f32_16x16x32_bf16 v[56:59], v[196:199], v[164:167], 0
    ds_read_b64_tr_b16 v[192:193], v13 offset:6144
    v_mfma_f32_16x16x32_bf16 v[92:95], v[196:199], v[168:171], 0
    ds_read_b64_tr_b16 v[194:195], v13 offset:6400
    v_mfma_f32_16x16x32_bf16 v[128:131], v[196:199], v[172:175], 0
    s_waitcnt lgkmcnt(12)
    v_mfma_f32_16x16x32_bf16 v[24:27], v[200:203], v[160:163], 0
    v_mfma_f32_16x16x32_bf16 v[60:63], v[200:203], v[164:167], 0
    ds_read_b64_tr_b16 v[196:197], v12 offset:10240
    v_mfma_f32_16x16x32_bf16 v[96:99], v[200:203], v[168:171], 0
    ds_read_b64_tr_b16 v[198:199], v12 offset:10496
    v_mfma_f32_16x16x32_bf16 v[132:135], v[200:203], v[172:175], 0
    v_mfma_f32_16x16x32_bf16 v[28:31], v[204:207], v[160:163], 0
    v_mfma_f32_16x16x32_bf16 v[64:67], v[204:207], v[164:167], 0
    ds_read_b64_tr_b16 v[200:201], v13 offset:10240
    v_mfma_f32_16x16x32_bf16 v[100:103], v[204:207], v[168:171], 0
    ds_read_b64_tr_b16 v[202:203], v13 offset:10496
    v_mfma_f32_16x16x32_bf16 v[136:139], v[204:207], v[172:175], 0
    v_mfma_f32_16x16x32_bf16 v[32:35], v[208:211], v[160:163], 0
    v_mfma_f32_16x16x32_bf16 v[68:71], v[208:211], v[164:167], 0
    ds_read_b64_tr_b16 v[204:205], v12 offset:14336
    v_mfma_f32_16x16x32_bf16 v[104:107], v[208:211], v[168:171], 0
    ds_read_b64_tr_b16 v[206:207], v12 offset:14592
    v_mfma_f32_16x16x32_bf16 v[140:143], v[208:211], v[172:175], 0
    v_mfma_f32_16x16x32_bf16 v[36:39], v[212:215], v[160:163], 0
    v_mfma_f32_16x16x32_bf16 v[72:75], v[212:215], v[164:167], 0
    ds_read_b64_tr_b16 v[208:209], v13 offset:14336
    v_mfma_f32_16x16x32_bf16 v[108:111], v[212:215], v[168:171], 0
    ds_read_b64_tr_b16 v[210:211], v13 offset:14592
    v_mfma_f32_16x16x32_bf16 v[144:147], v[212:215], v[172:175], 0
    v_mfma_f32_16x16x32_bf16 v[40:43], v[216:219], v[160:163], 0
    v_mfma_f32_16x16x32_bf16 v[76:79], v[216:219], v[164:167], 0
    ds_read_b64_tr_b16 v[212:213], v14 offset:2048
    v_mfma_f32_16x16x32_bf16 v[112:115], v[216:219], v[168:171], 0
    ds_read_b64_tr_b16 v[214:215], v14 offset:2304
    v_mfma_f32_16x16x32_bf16 v[148:151], v[216:219], v[172:175], 0
    v_mfma_f32_16x16x32_bf16 v[44:47], v[220:223], v[160:163], 0
    v_mfma_f32_16x16x32_bf16 v[80:83], v[220:223], v[164:167], 0
    v_mfma_f32_16x16x32_bf16 v[116:119], v[220:223], v[168:171], 0
    v_add_u32 v10, s61, v10
    v_mfma_f32_16x16x32_bf16 v[152:155], v[220:223], v[172:175], 0
    v_add_u32 v11, s61, v11
    v_mfma_f32_16x16x32_bf16 v[48:51], v[224:227], v[160:163], 0
    v_add_u32 v12, s61, v12
    v_mfma_f32_16x16x32_bf16 v[84:87], v[224:227], v[164:167], 0
    v_add_u32 v13, s61, v13
    v_mfma_f32_16x16x32_bf16 v[120:123], v[224:227], v[168:171], 0
    v_add_u32 v14, s61, v14
    v_mfma_f32_16x16x32_bf16 v[156:159], v[224:227], v[172:175], 0
    s_waitcnt lgkmcnt(0)
    .p2align 6
LG_l1:
    s_barrier
    v_mfma_f32_16x16x32_bf16 v[16:19], v[228:231], v[176:179], v[16:19]
    ds_read_b128 v[160:163], v11 offset:0
    v_mfma_f32_16x16x32_bf16 v[52:55], v[228:231], v[180:183], v[52:55]
    ds_read_b128 v[164:167], v11 offset:2048
    v_mfma_f32_16x16x32_bf16 v[88:91], v[228:231], v[184:187], v[88:91]
    ds_read_b128 v[168:171], v11 offset:4096
    v_mfma_f32_16x16x32_bf16 v[124:127], v[228:231], v[188:191], v[124:127]
    ds_read_b128 v[172:175], v11 offset:6144
    v_mfma_f32_16x16x32_bf16 v[20:23], v[232:235], v[176:179], v[20:23]
    ds_read_b64_tr_b16 v[216:217], v12 offset:12288
    v_mfma_f32_16x16x32_bf16 v[56:59], v[232:235], v[180:183], v[56:59]
    ds_read_b64_tr_b16 v[218:219], v12 offset:12544
    v_mfma_f32_16x16x32_bf16 v[92:95], v[232:235], v[184:187], v[92:95]
    ds_read_b64_tr_b16 v[220:221], v13 offset:12288
    v_mfma_f32_16x16x32_bf16 v[128:131], v[232:235], v[188:191], v[128:131]
    ds_read_b64_tr_b16 v[222:223], v13 offset:12544
    v_mfma_f32_16x16x32_bf16 v[24:27], v[236:239], v[176:179], v[24:27]
    ds_read_b64_tr_b16 v[224:225], v14 offset:0
    v_mfma_f32_16x16x32_bf16 v[60:63], v[236:239], v[180:183], v[60:63]
    ds_read_b64_tr_b16 v[226:227], v14 offset:256
    v_mfma_f32_16x16x32_bf16 v[96:99], v[236:239], v[184:187], v[96:99]
    s_mov_b32 s58, s60
    s_add_u32 s60, s58, 53248
    v_mfma_f32_16x16x32_bf16 v[132:135], v[236:239], v[188:191], v[132:135]
    s_cmp_eq_u32 s60, 159744
    s_cselect_b32 s60, 0, s60
    v_mfma_f32_16x16x32_bf16 v[28:31], v[192:195], v[176:179], v[28:31]
    v_mfma_f32_16x16x32_bf16 v[64:67], v[192:195], v[180:183], v[64:67]
    v_mfma_f32_16x16x32_bf16 v[100:103], v[192:195], v[184:187], v[100:103]
    s_sub_u32 s61, s60, s58
    v_mfma_f32_16x16x32_bf16 v[136:139], v[192:195], v[188:191], v[136:139]
    s_add_u32 s59, s59, 1
    v_mfma_f32_16x16x32_bf16 v[32:35], v[196:199], v[176:179], v[32:35]
    ds_read_b64_tr_b16 v[192:193], v12 offset:0
    v_mfma_f32_16x16x32_bf16 v[68:71], v[196:199], v[180:183], v[68:71]
    ds_read_b64_tr_b16 v[194:195], v12 offset:256
    v_mfma_f32_16x16x32_bf16 v[104:107], v[196:199], v[184:187], v[104:107]
    v_mfma_f32_16x16x32_bf16 v[140:143], v[196:199], v[188:191], v[140:143]
    v_mfma_f32_16x16x32_bf16 v[36:39], v[200:203], v[176:179], v[36:39]
    ds_read_b64_tr_b16 v[196:197], v13 offset:0
    v_mfma_f32_16x16x32_bf16 v[72:75], v[200:203], v[180:183], v[72:75]
    ds_read_b64_tr_b16 v[198:199], v13 offset:256
    v_mfma_f32_16x16x32_bf16 v[108:111], v[200:203], v[184:187], v[108:111]
    v_mfma_f32_16x16x32_bf16 v[144:147], v[200:203], v[188:191], v[144:147]
    v_mfma_f32_16x16x32_bf16 v[40:43], v[204:207], v[176:179], v[40:43]
    ds_read_b64_tr_b16 v[200:201], v12 offset:4096
    v_mfma_f32_16x16x32_bf16 v[76:79], v[204:207], v[180:183], v[76:79]
    ds_read_b64_tr_b16 v[202:203], v12 offset:4352
    v_mfma_f32_16x16x32_bf16 v[112:115], v[204:207], v[184:187], v[112:115]
    v_mfma_f32_16x16x32_bf16 v[148:151], v[204:207], v[188:191], v[148:151]
    v_mfma_f32_16x16x32_bf16 v[44:47], v[208:211], v[176:179], v[44:47]
    ds_read_b64_tr_b16 v[204:205], v13 offset:4096
    v_mfma_f32_16x16x32_bf16 v[80:83], v[208:211], v[180:183], v[80:83]
    ds_read_b64_tr_b16 v[206:207], v13 offset:4352
    v_mfma_f32_16x16x32_bf16 v[116:119], v[208:211], v[184:187], v[116:119]
    v_mfma_f32_16x16x32_bf16 v[152:155], v[208:211], v[188:191], v[152:155]
    v_mfma_f32_16x16x32_bf16 v[48:51], v[212:215], v[176:179], v[48:51]
    ds_read_b64_tr_b16 v[208:209], v12 offset:8192
    v_mfma_f32_16x16x32_bf16 v[84:87], v[212:215], v[180:183], v[84:87]
    ds_read_b64_tr_b16 v[210:211], v12 offset:8448
    v_mfma_f32_16x16x32_bf16 v[120:123], v[212:215], v[184:187], v[120:123]
    v_mfma_f32_16x16x32_bf16 v[156:159], v[212:215], v[188:191], v[156:159]
    ds_read_b64_tr_b16 v[212:213], v13 offset:8192
    ds_read_b64_tr_b16 v[214:215], v13 offset:8448
    s_waitcnt lgkmcnt(4)
    v_mfma_f32_16x16x32_bf16 v[16:19], v[192:195], v[160:163], v[16:19]
    ds_read_b128 v[176:179], v10 offset:0
    ds_read_b128 v[180:183], v10 offset:2048
    v_mfma_f32_16x16x32_bf16 v[52:55], v[192:195], v[164:167], v[52:55]
    ds_read_b128 v[184:187], v10 offset:4096
    ds_read_b128 v[188:191], v10 offset:6144
    v_mfma_f32_16x16x32_bf16 v[88:91], v[192:195], v[168:171], v[88:91]
    ds_read_b64_tr_b16 v[228:229], v12 offset:2048
    ds_read_b64_tr_b16 v[230:231], v12 offset:2304
    v_mfma_f32_16x16x32_bf16 v[124:127], v[192:195], v[172:175], v[124:127]
    ds_read_b64_tr_b16 v[232:233], v13 offset:2048
    ds_read_b64_tr_b16 v[234:235], v13 offset:2304
    v_mfma_f32_16x16x32_bf16 v[20:23], v[196:199], v[160:163], v[20:23]
    ds_read_b64_tr_b16 v[236:237], v12 offset:6144
    ds_read_b64_tr_b16 v[238:239], v12 offset:6400
    v_mfma_f32_16x16x32_bf16 v[56:59], v[196:199], v[164:167], v[56:59]
    ds_read_b64_tr_b16 v[192:193], v13 offset:6144
    v_mfma_f32_16x16x32_bf16 v[92:95], v[196:199], v[168:171], v[92:95]
    ds_read_b64_tr_b16 v[194:195], v13 offset:6400
    v_mfma_f32_16x16x32_bf16 v[128:131], v[196:199], v[172:175], v[128:131]
    s_waitcnt lgkmcnt(12)
    v_mfma_f32_16x16x32_bf16 v[24:27], v[200:203], v[160:163], v[24:27]
    v_mfma_f32_16x16x32_bf16 v[60:63], v[200:203], v[164:167], v[60:63]
    ds_read_b64_tr_b16 v[196:197], v12 offset:10240
    v_mfma_f32_16x16x32_bf16 v[96:99], v[200:203], v[168:171], v[96:99]
    ds_read_b64_tr_b16 v[198:199], v12 offset:10496
    v_mfma_f32_16x16x32_bf16 v[132:135], v[200:203], v[172:175], v[132:135]
    v_mfma_f32_16x16x32_bf16 v[28:31], v[204:207], v[160:163], v[28:31]
    v_mfma_f32_16x16x32_bf16 v[64:67], v[204:207], v[164:167], v[64:67]
    ds_read_b64_tr_b16 v[200:201], v13 offset:10240
    v_mfma_f32_16x16x32_bf16 v[100:103], v[204:207], v[168:171], v[100:103]
    ds_read_b64_tr_b16 v[202:203], v13 offset:10496
    v_mfma_f32_16x16x32_bf16 v[136:139], v[204:207], v[172:175], v[136:139]
    v_mfma_f32_16x16x32_bf16 v[32:35], v[208:211], v[160:163], v[32:35]
    v_mfma_f32_16x16x32_bf16 v[68:71], v[208:211], v[164:167], v[68:71]
    ds_read_b64_tr_b16 v[204:205], v12 offset:14336
    v_mfma_f32_16x16x32_bf16 v[104:107], v[208:211], v[168:171], v[104:107]
    ds_read_b64_tr_b16 v[206:207], v12 offset:14592
    v_mfma_f32_16x16x32_bf16 v[140:143], v[208:211], v[172:175], v[140:143]
    v_mfma_f32_16x16x32_bf16 v[36:39], v[212:215], v[160:163], v[36:39]
    v_mfma_f32_16x16x32_bf16 v[72:75], v[212:215], v[164:167], v[72:75]
    ds_read_b64_tr_b16 v[208:209], v13 offset:14336
    v_mfma_f32_16x16x32_bf16 v[108:111], v[212:215], v[168:171], v[108:111]
    ds_read_b64_tr_b16 v[210:211], v13 offset:14592
    v_mfma_f32_16x16x32_bf16 v[144:147], v[212:215], v[172:175], v[144:147]
    v_mfma_f32_16x16x32_bf16 v[40:43], v[216:219], v[160:163], v[40:43]
    v_mfma_f32_16x16x32_bf16 v[76:79], v[216:219], v[164:167], v[76:79]
    ds_read_b64_tr_b16 v[212:213], v14 offset:2048
    v_mfma_f32_16x16x32_bf16 v[112:115], v[216:219], v[168:171], v[112:115]
    ds_read_b64_tr_b16 v[214:215], v14 offset:2304
    v_mfma_f32_16x16x32_bf16 v[148:151], v[216:219], v[172:175], v[148:151]
    v_mfma_f32_16x16x32_bf16 v[44:47], v[220:223], v[160:163], v[44:47]
    v_mfma_f32_16x16x32_bf16 v[80:83], v[220:223], v[164:167], v[80:83]
    v_mfma_f32_16x16x32_bf16 v[116:119], v[220:223], v[168:171], v[116:119]
    v_add_u32 v10, s61, v10
    v_mfma_f32_16x16x32_bf16 v[152:155], v[220:223], v[172:175], v[152:155]
    v_add_u32 v11, s61, v11
    v_mfma_f32_16x16x32_bf16 v[48:51], v[224:227], v[160:163], v[48:51]
    v_add_u32 v12, s61, v12
    v_mfma_f32_16x16x32_bf16 v[84:87], v[224:227], v[164:167], v[84:87]
    v_add_u32 v13, s61, v13
    v_mfma_f32_16x16x32_bf16 v[120:123], v[224:227], v[168:171], v[120:123]
    v_add_u32 v14, s61, v14
    v_mfma_f32_16x16x32_bf16 v[156:159], v[224:227], v[172:175], v[156:159]
    s_cmp_lt_u32 s59, 15
    s_waitcnt lgkmcnt(0)
    s_cbranch_scc1 LG_l1
    v_mfma_f32_16x16x32_bf16 v[16:19], v[228:231], v[176:179], v[16:19]
    s_mov_b32 s62, 0x3eeff558
    s_mov_b32 s63, 0x3eeff558
    s_lshl_b32 s47, s44, 11
    v_mfma_f32_16x16x32_bf16 v[52:55], v[228:231], v[180:183], v[52:55]
    s_add_u32 s47, s47, 57344
    v_lshlrev_b32 v12, 5, v3
    v_add_u32 v12, s47, v12
    v_mfma_f32_16x16x32_bf16 v[88:91], v[228:231], v[184:187], v[88:91]
    s_lshl_b32 s47, s45, 9
    s_add_u32 s47, s47, 53248
    v_lshlrev_b32 v13, 4, v4
    v_mfma_f32_16x16x32_bf16 v[124:127], v[228:231], v[188:191], v[124:127]
    v_add_u32 v14, s47, v13
    ds_read_b64 v[240:241], v12 offset:16
    ds_read_b64 v[242:243], v12 offset:528
    v_mfma_f32_16x16x32_bf16 v[20:23], v[232:235], v[176:179], v[20:23]
    ds_read_b64 v[244:245], v12 offset:1040
    ds_read_b64 v[246:247], v12 offset:1552
    ds_read_b128 v[220:223], v14 offset:0
    v_mfma_f32_16x16x32_bf16 v[56:59], v[232:235], v[180:183], v[56:59]
    ds_read_b128 v[224:227], v14 offset:64
    ds_read_b128 v[160:163], v12 offset:0
    ds_read_b128 v[164:167], v12 offset:512
    v_mfma_f32_16x16x32_bf16 v[92:95], v[232:235], v[184:187], v[92:95]
    ds_read_b128 v[168:171], v12 offset:1024
    ds_read_b128 v[172:175], v12 offset:1536
    s_lshl_b32 s47, s45, 9
    v_mfma_f32_16x16x32_bf16 v[128:131], v[232:235], v[188:191], v[128:131]
    s_add_u32 s47, s47, 53248
    v_add_u32 v12, s47, v13
    s_lshl_b32 s47, s45, 6
    v_mfma_f32_16x16x32_bf16 v[24:27], v[236:239], v[176:179], v[24:27]
    s_add_u32 s47, s47, 53632
    v_add_u32 v13, s47, v13
    s_lshl_b32 s46, s41, 3
    v_mfma_f32_16x16x32_bf16 v[60:63], v[236:239], v[180:183], v[60:63]
    s_lshl_b32 s47, s44, 2
    s_add_u32 s46, s46, s47
    s_mul_i32 s48, s46, 147456
    v_mfma_f32_16x16x32_bf16 v[96:99], v[236:239], v[184:187], v[96:99]
    s_mul_i32 s49, s42, 7168
    s_add_u32 s48, s48, s49
    s_add_u32 s48, s48, 0x1008000
    v_mfma_f32_16x16x32_bf16 v[132:135], v[236:239], v[188:191], v[132:135]
    s_add_u32 s49, s48, 147456
    s_add_u32 s50, s48, 294912
    s_add_u32 s51, s48, 442368
    v_mfma_f32_16x16x32_bf16 v[28:31], v[192:195], v[176:179], v[28:31]
    s_lshl_b32 s47, s45, 12
    v_add_u32 v6, s47, v5
    s_lshl_b32 s47, s45, 3
    v_mfma_f32_16x16x32_bf16 v[64:67], v[192:195], v[180:183], v[64:67]
    v_add_u32 v7, s47, v5
    s_lshl_b32 s47, s44, 13
    s_lshl_b32 s52, s45, 10
    v_mfma_f32_16x16x32_bf16 v[100:103], v[192:195], v[184:187], v[100:103]
    s_add_u32 s47, s47, s52
    s_add_u32 s47, s47, 143360
    v_add_u32 v10, s47, v5
    v_mfma_f32_16x16x32_bf16 v[136:139], v[192:195], v[188:191], v[136:139]
    v_mov_b32 v8, 0x409d30fc
    v_mov_b32 v9, 0x409d30fc
    v_mov_b32 v11, 1
    v_mfma_f32_16x16x32_bf16 v[32:35], v[196:199], v[176:179], v[32:35]
    v_mfma_f32_16x16x32_bf16 v[68:71], v[196:199], v[180:183], v[68:71]
    s_waitcnt lgkmcnt(0)
    v_mul_f32 v16, v240, v16
    v_mfma_f32_16x16x32_bf16 v[104:107], v[196:199], v[184:187], v[104:107]
    v_fmac_f32 v16, v241, v220
    v_mul_f32 v17, v240, v17
    v_mfma_f32_16x16x32_bf16 v[140:143], v[196:199], v[188:191], v[140:143]
    v_fmac_f32 v17, v241, v221
    v_mul_f32 v18, v240, v18
    v_mfma_f32_16x16x32_bf16 v[36:39], v[200:203], v[176:179], v[36:39]
    v_fmac_f32 v18, v241, v222
    v_mul_f32 v19, v240, v19
    v_mfma_f32_16x16x32_bf16 v[72:75], v[200:203], v[180:183], v[72:75]
    v_fmac_f32 v19, v241, v223
    v_mul_f32 v20, v240, v20
    v_mfma_f32_16x16x32_bf16 v[108:111], v[200:203], v[184:187], v[108:111]
    v_fmac_f32 v20, v241, v224
    v_mul_f32 v21, v240, v21
    v_mfma_f32_16x16x32_bf16 v[144:147], v[200:203], v[188:191], v[144:147]
    v_fmac_f32 v21, v241, v225
    v_mul_f32 v22, v240, v22
    v_mfma_f32_16x16x32_bf16 v[40:43], v[204:207], v[176:179], v[40:43]
    v_fmac_f32 v22, v241, v226
    v_mul_f32 v23, v240, v23
    v_mfma_f32_16x16x32_bf16 v[76:79], v[204:207], v[180:183], v[76:79]
    v_fmac_f32 v23, v241, v227
    v_mul_f32 v52, v242, v52
    v_mfma_f32_16x16x32_bf16 v[112:115], v[204:207], v[184:187], v[112:115]
    v_fmac_f32 v52, v243, v220
    v_mul_f32 v53, v242, v53
    v_mfma_f32_16x16x32_bf16 v[148:151], v[204:207], v[188:191], v[148:151]
    v_fmac_f32 v53, v243, v221
    v_mul_f32 v54, v242, v54
    v_mfma_f32_16x16x32_bf16 v[44:47], v[208:211], v[176:179], v[44:47]
    v_fmac_f32 v54, v243, v222
    v_mul_f32 v55, v242, v55
    v_mfma_f32_16x16x32_bf16 v[80:83], v[208:211], v[180:183], v[80:83]
    v_fmac_f32 v55, v243, v223
    v_mul_f32 v56, v242, v56
    v_mfma_f32_16x16x32_bf16 v[116:119], v[208:211], v[184:187], v[116:119]
    v_fmac_f32 v56, v243, v224
    v_mul_f32 v57, v242, v57
    v_mfma_f32_16x16x32_bf16 v[152:155], v[208:211], v[188:191], v[152:155]
    v_fmac_f32 v57, v243, v225
    v_mul_f32 v58, v242, v58
    v_mfma_f32_16x16x32_bf16 v[48:51], v[212:215], v[176:179], v[48:51]
    v_fmac_f32 v58, v243, v226
    v_mul_f32 v59, v242, v59
    v_mfma_f32_16x16x32_bf16 v[84:87], v[212:215], v[180:183], v[84:87]
    v_fmac_f32 v59, v243, v227
    v_mul_f32 v88, v244, v88
    v_mfma_f32_16x16x32_bf16 v[120:123], v[212:215], v[184:187], v[120:123]
    v_fmac_f32 v88, v245, v220
    v_mul_f32 v89, v244, v89
    v_mfma_f32_16x16x32_bf16 v[156:159], v[212:215], v[188:191], v[156:159]
    v_fmac_f32 v89, v245, v221
    v_mul_f32 v90, v244, v90
    v_fmac_f32 v90, v245, v222
LG_epi:
    s_setprio 2
    ds_read_b128 v[200:203], v12 offset:128
    ds_read_b128 v[204:207], v12 offset:192
    ds_read_b128 v[208:211], v12 offset:2048
    ds_read_b128 v[212:215], v12 offset:2112
    v_mul_f32 v91, v244, v91
    v_fmac_f32 v91, v245, v223
    v_mul_f32 v92, v244, v92
    v_fmac_f32 v92, v245, v224
    v_mul_f32 v93, v244, v93
    v_fmac_f32 v93, v245, v225
    v_mul_f32 v94, v244, v94
    v_fmac_f32 v94, v245, v226
    v_mul_f32 v95, v244, v95
    v_fmac_f32 v95, v245, v227
    v_mul_f32 v124, v246, v124
    v_fmac_f32 v124, v247, v220
    v_mul_f32 v125, v246, v125
    v_fmac_f32 v125, v247, v221
    v_mul_f32 v126, v246, v126
    v_fmac_f32 v126, v247, v222
    v_mul_f32 v127, v246, v127
    v_fmac_f32 v127, v247, v223
    v_mul_f32 v128, v246, v128
    v_fmac_f32 v128, v247, v224
    v_mul_f32 v129, v246, v129
    v_fmac_f32 v129, v247, v225
    v_mul_f32 v130, v246, v130
    v_fmac_f32 v130, v247, v226
    v_mul_f32 v131, v246, v131
    v_fmac_f32 v131, v247, v227
    v_cvt_pk_bf16_f32 v176, v16, v17
    v_cvt_pk_bf16_f32 v177, v18, v19
    v_cvt_pk_bf16_f32 v178, v20, v21
    v_cvt_pk_bf16_f32 v179, v22, v23
    ds_write_b128 v10, v[176:179] offset:0
    v_cvt_pk_bf16_f32 v180, v52, v53
    v_cvt_pk_bf16_f32 v181, v54, v55
    v_cvt_pk_bf16_f32 v182, v56, v57
    v_cvt_pk_bf16_f32 v183, v58, v59
    ds_write_b128 v10, v[180:183] offset:2048
    v_cvt_pk_bf16_f32 v184, v88, v89
    v_cvt_pk_bf16_f32 v185, v90, v91
    v_cvt_pk_bf16_f32 v186, v92, v93
    v_cvt_pk_bf16_f32 v187, v94, v95
    ds_write_b128 v10, v[184:187] offset:4096
    v_cvt_pk_bf16_f32 v188, v124, v125
    v_cvt_pk_bf16_f32 v189, v126, v127
    v_cvt_pk_bf16_f32 v190, v128, v129
    v_cvt_pk_bf16_f32 v191, v130, v131
    ds_write_b128 v10, v[188:191] offset:6144
    ds_write_b32 v254, v11 offset:16
    s_load_dwordx2 s[4:5], s[0:1], 32
    s_load_dwordx4 s[8:11], s[0:1], 64
    s_load_dwordx2 s[32:33], s[0:1], 0
    s_load_dwordx2 s[34:35], s[0:1], 80
    s_waitcnt lgkmcnt(0)
    ds_read_b128 v[232:235], v12 offset:256
    ds_read_b128 v[236:239], v12 offset:320
    ds_read_b128 v[240:243], v12 offset:2176
    ds_read_b128 v[244:247], v12 offset:2240
    v_pk_fma_f32 v[192:193], v[200:201], v[162:163], v[208:209]
    v_pk_fma_f32 v[194:195], v[202:203], v[162:163], v[210:211]
    v_pk_fma_f32 v[196:197], v[204:205], v[162:163], v[212:213]
    v_pk_fma_f32 v[198:199], v[206:207], v[162:163], v[214:215]
    v_pk_fma_f32 v[24:25], v[24:25], v[160:161], v[192:193]
    v_pk_fma_f32 v[26:27], v[26:27], v[160:161], v[194:195]
    v_pk_fma_f32 v[28:29], v[28:29], v[160:161], v[196:197]
    v_pk_fma_f32 v[30:31], v[30:31], v[160:161], v[198:199]
    v_pk_fma_f32 v[192:193], v[24:25], v[24:25], v[8:9]
    v_pk_fma_f32 v[194:195], v[26:27], v[26:27], v[8:9]
    v_pk_fma_f32 v[196:197], v[28:29], v[28:29], v[8:9]
    v_pk_fma_f32 v[198:199], v[30:31], v[30:31], v[8:9]
    v_pk_mul_f32 v[192:193], v[192:193], v[24:25] neg_lo:[0,1] neg_hi:[0,1]
    v_pk_mul_f32 v[194:195], v[194:195], v[26:27] neg_lo:[0,1] neg_hi:[0,1]
    v_pk_mul_f32 v[196:197], v[196:197], v[28:29] neg_lo:[0,1] neg_hi:[0,1]
    v_pk_mul_f32 v[198:199], v[198:199], v[30:31] neg_lo:[0,1] neg_hi:[0,1]
    v_exp_f32 v192, v192
    v_exp_f32 v193, v193
    v_exp_f32 v194, v194
    v_exp_f32 v195, v195
    v_exp_f32 v196, v196
    v_exp_f32 v197, v197
    v_exp_f32 v198, v198
    v_exp_f32 v199, v199
    v_pk_fma_f32 v[192:193], v[192:193], s[62:63], s[62:63]
    v_pk_fma_f32 v[194:195], v[194:195], s[62:63], s[62:63]
    v_pk_fma_f32 v[196:197], v[196:197], s[62:63], s[62:63]
    v_pk_fma_f32 v[198:199], v[198:199], s[62:63], s[62:63]
    v_rcp_f32 v192, v192
    v_rcp_f32 v193, v193
    v_rcp_f32 v194, v194
    v_rcp_f32 v195, v195
    v_rcp_f32 v196, v196
    v_rcp_f32 v197, v197
    v_rcp_f32 v198, v198
    v_rcp_f32 v199, v199
    v_pk_mul_f32 v[24:25], v[24:25], v[192:193]
    v_pk_mul_f32 v[26:27], v[26:27], v[194:195]
    v_pk_mul_f32 v[28:29], v[28:29], v[196:197]
    v_pk_mul_f32 v[30:31], v[30:31], v[198:199]
    v_cvt_pk_bf16_f32 v176, v24, v25
    v_cvt_pk_bf16_f32 v177, v26, v27
    v_cvt_pk_bf16_f32 v178, v28, v29
    v_cvt_pk_bf16_f32 v179, v30, v31
    s_waitcnt vmcnt(2)
    buffer_store_dwordx4 v[176:179], v6, s[24:27], s48 offen offset:0 sc1
    v_pk_fma_f32 v[216:217], v[200:201], v[166:167], v[208:209]
    v_pk_fma_f32 v[218:219], v[202:203], v[166:167], v[210:211]
    v_pk_fma_f32 v[220:221], v[204:205], v[166:167], v[212:213]
    v_pk_fma_f32 v[222:223], v[206:207], v[166:167], v[214:215]
    v_pk_fma_f32 v[60:61], v[60:61], v[164:165], v[216:217]
    v_pk_fma_f32 v[62:63], v[62:63], v[164:165], v[218:219]
    v_pk_fma_f32 v[64:65], v[64:65], v[164:165], v[220:221]
    v_pk_fma_f32 v[66:67], v[66:67], v[164:165], v[222:223]
    v_pk_fma_f32 v[216:217], v[60:61], v[60:61], v[8:9]
    v_pk_fma_f32 v[218:219], v[62:63], v[62:63], v[8:9]
    v_pk_fma_f32 v[220:221], v[64:65], v[64:65], v[8:9]
    v_pk_fma_f32 v[222:223], v[66:67], v[66:67], v[8:9]
    v_pk_mul_f32 v[216:217], v[216:217], v[60:61] neg_lo:[0,1] neg_hi:[0,1]
    v_pk_mul_f32 v[218:219], v[218:219], v[62:63] neg_lo:[0,1] neg_hi:[0,1]
    v_pk_mul_f32 v[220:221], v[220:221], v[64:65] neg_lo:[0,1] neg_hi:[0,1]
    v_pk_mul_f32 v[222:223], v[222:223], v[66:67] neg_lo:[0,1] neg_hi:[0,1]
    v_exp_f32 v216, v216
    v_exp_f32 v217, v217
    v_exp_f32 v218, v218
    v_exp_f32 v219, v219
    v_exp_f32 v220, v220
    v_exp_f32 v221, v221
    v_exp_f32 v222, v222
    v_exp_f32 v223, v223
    v_pk_fma_f32 v[216:217], v[216:217], s[62:63], s[62:63]
    v_pk_fma_f32 v[218:219], v[218:219], s[62:63], s[62:63]
    v_pk_fma_f32 v[220:221], v[220:221], s[62:63], s[62:63]
    v_pk_fma_f32 v[222:223], v[222:223], s[62:63], s[62:63]
    v_rcp_f32 v216, v216
    v_rcp_f32 v217, v217
    v_rcp_f32 v218, v218
    v_rcp_f32 v219, v219
    v_rcp_f32 v220, v220
    v_rcp_f32 v221, v221
    v_rcp_f32 v222, v222
    v_rcp_f32 v223, v223
    v_pk_mul_f32 v[60:61], v[60:61], v[216:217]
    v_pk_mul_f32 v[62:63], v[62:63], v[218:219]
    v_pk_mul_f32 v[64:65], v[64:65], v[220:221]
    v_pk_mul_f32 v[66:67], v[66:67], v[222:223]
    v_cvt_pk_bf16_f32 v180, v60, v61
    v_cvt_pk_bf16_f32 v181, v62, v63
    v_cvt_pk_bf16_f32 v182, v64, v65
    v_cvt_pk_bf16_f32 v183, v66, v67
    s_waitcnt vmcnt(2)
    buffer_store_dwordx4 v[180:183], v6, s[24:27], s49 offen offset:0 sc1
    v_pk_fma_f32 v[192:193], v[200:201], v[170:171], v[208:209]
    v_pk_fma_f32 v[194:195], v[202:203], v[170:171], v[210:211]
    v_pk_fma_f32 v[196:197], v[204:205], v[170:171], v[212:213]
    v_pk_fma_f32 v[198:199], v[206:207], v[170:171], v[214:215]
    v_pk_fma_f32 v[96:97], v[96:97], v[168:169], v[192:193]
    v_pk_fma_f32 v[98:99], v[98:99], v[168:169], v[194:195]
    v_pk_fma_f32 v[100:101], v[100:101], v[168:169], v[196:197]
    v_pk_fma_f32 v[102:103], v[102:103], v[168:169], v[198:199]
    v_pk_fma_f32 v[192:193], v[96:97], v[96:97], v[8:9]
    v_pk_fma_f32 v[194:195], v[98:99], v[98:99], v[8:9]
    v_pk_fma_f32 v[196:197], v[100:101], v[100:101], v[8:9]
    v_pk_fma_f32 v[198:199], v[102:103], v[102:103], v[8:9]
    v_pk_mul_f32 v[192:193], v[192:193], v[96:97] neg_lo:[0,1] neg_hi:[0,1]
    v_pk_mul_f32 v[194:195], v[194:195], v[98:99] neg_lo:[0,1] neg_hi:[0,1]
    v_pk_mul_f32 v[196:197], v[196:197], v[100:101] neg_lo:[0,1] neg_hi:[0,1]
    v_pk_mul_f32 v[198:199], v[198:199], v[102:103] neg_lo:[0,1] neg_hi:[0,1]
    v_exp_f32 v192, v192
    v_exp_f32 v193, v193
    v_exp_f32 v194, v194
    v_exp_f32 v195, v195
    v_exp_f32 v196, v196
    v_exp_f32 v197, v197
    v_exp_f32 v198, v198
    v_exp_f32 v199, v199
    v_pk_fma_f32 v[192:193], v[192:193], s[62:63], s[62:63]
    v_pk_fma_f32 v[194:195], v[194:195], s[62:63], s[62:63]
    v_pk_fma_f32 v[196:197], v[196:197], s[62:63], s[62:63]
    v_pk_fma_f32 v[198:199], v[198:199], s[62:63], s[62:63]
    v_rcp_f32 v192, v192
    v_rcp_f32 v193, v193
    v_rcp_f32 v194, v194
    v_rcp_f32 v195, v195
    v_rcp_f32 v196, v196
    v_rcp_f32 v197, v197
    v_rcp_f32 v198, v198
    v_rcp_f32 v199, v199
    v_pk_mul_f32 v[96:97], v[96:97], v[192:193]
    v_pk_mul_f32 v[98:99], v[98:99], v[194:195]
    v_pk_mul_f32 v[100:101], v[100:101], v[196:197]
    v_pk_mul_f32 v[102:103], v[102:103], v[198:199]
    v_cvt_pk_bf16_f32 v184, v96, v97
    v_cvt_pk_bf16_f32 v185, v98, v99
    v_cvt_pk_bf16_f32 v186, v100, v101
    v_cvt_pk_bf16_f32 v187, v102, v103
    s_waitcnt vmcnt(2)
    buffer_store_dwordx4 v[184:187], v6, s[24:27], s50 offen offset:0 sc1
    v_pk_fma_f32 v[216:217], v[200:201], v[174:175], v[208:209]
    v_pk_fma_f32 v[218:219], v[202:203], v[174:175], v[210:211]
    v_pk_fma_f32 v[220:221], v[204:205], v[174:175], v[212:213]
    v_pk_fma_f32 v[222:223], v[206:207], v[174:175], v[214:215]
    v_pk_fma_f32 v[132:133], v[132:133], v[172:173], v[216:217]
    v_pk_fma_f32 v[134:135], v[134:135], v[172:173], v[218:219]
    v_pk_fma_f32 v[136:137], v[136:137], v[172:173], v[220:221]
    v_pk_fma_f32 v[138:139], v[138:139], v[172:173], v[222:223]
    v_pk_fma_f32 v[216:217], v[132:133], v[132:133], v[8:9]
    v_pk_fma_f32 v[218:219], v[134:135], v[134:135], v[8:9]
    v_pk_fma_f32 v[220:221], v[136:137], v[136:137], v[8:9]
    v_pk_fma_f32 v[222:223], v[138:139], v[138:139], v[8:9]
    v_pk_mul_f32 v[216:217], v[216:217], v[132:133] neg_lo:[0,1] neg_hi:[0,1]
    v_pk_mul_f32 v[218:219], v[218:219], v[134:135] neg_lo:[0,1] neg_hi:[0,1]
    v_pk_mul_f32 v[220:221], v[220:221], v[136:137] neg_lo:[0,1] neg_hi:[0,1]
    v_pk_mul_f32 v[222:223], v[222:223], v[138:139] neg_lo:[0,1] neg_hi:[0,1]
    v_exp_f32 v216, v216
    v_exp_f32 v217, v217
    v_exp_f32 v218, v218
    v_exp_f32 v219, v219
    v_exp_f32 v220, v220
    v_exp_f32 v221, v221
    v_exp_f32 v222, v222
    v_exp_f32 v223, v223
    v_pk_fma_f32 v[216:217], v[216:217], s[62:63], s[62:63]
    v_pk_fma_f32 v[218:219], v[218:219], s[62:63], s[62:63]
    v_pk_fma_f32 v[220:221], v[220:221], s[62:63], s[62:63]
    v_pk_fma_f32 v[222:223], v[222:223], s[62:63], s[62:63]
    v_rcp_f32 v216, v216
    v_rcp_f32 v217, v217
    v_rcp_f32 v218, v218
    v_rcp_f32 v219, v219
    v_rcp_f32 v220, v220
    v_rcp_f32 v221, v221
    v_rcp_f32 v222, v222
    v_rcp_f32 v223, v223
    v_pk_mul_f32 v[132:133], v[132:133], v[216:217]
    v_pk_mul_f32 v[134:135], v[134:135], v[218:219]
    v_pk_mul_f32 v[136:137], v[136:137], v[220:221]
    v_pk_mul_f32 v[138:139], v[138:139], v[222:223]
    v_cvt_pk_bf16_f32 v188, v132, v133
    v_cvt_pk_bf16_f32 v189, v134, v135
    v_cvt_pk_bf16_f32 v190, v136, v137
    v_cvt_pk_bf16_f32 v191, v138, v139
    s_waitcnt vmcnt(2)
    buffer_store_dwordx4 v[188:191], v6, s[24:27], s51 offen offset:0 sc1
    s_waitcnt lgkmcnt(0)
    ds_read_b128 v[200:203], v12 offset:384
    ds_read_b128 v[204:207], v12 offset:448
    ds_read_b128 v[208:211], v12 offset:2304
    ds_read_b128 v[212:215], v12 offset:2368
    v_pk_fma_f32 v[192:193], v[232:233], v[162:163], v[240:241]
    v_pk_fma_f32 v[194:195], v[234:235], v[162:163], v[242:243]
    v_pk_fma_f32 v[196:197], v[236:237], v[162:163], v[244:245]
    v_pk_fma_f32 v[198:199], v[238:239], v[162:163], v[246:247]
    v_pk_fma_f32 v[32:33], v[32:33], v[160:161], v[192:193]
    v_pk_fma_f32 v[34:35], v[34:35], v[160:161], v[194:195]
    v_pk_fma_f32 v[36:37], v[36:37], v[160:161], v[196:197]
    v_pk_fma_f32 v[38:39], v[38:39], v[160:161], v[198:199]
    v_pk_fma_f32 v[192:193], v[32:33], v[32:33], v[8:9]
    v_pk_fma_f32 v[194:195], v[34:35], v[34:35], v[8:9]
    v_pk_fma_f32 v[196:197], v[36:37], v[36:37], v[8:9]
    v_pk_fma_f32 v[198:199], v[38:39], v[38:39], v[8:9]
    v_pk_mul_f32 v[192:193], v[192:193], v[32:33] neg_lo:[0,1] neg_hi:[0,1]
    v_pk_mul_f32 v[194:195], v[194:195], v[34:35] neg_lo:[0,1] neg_hi:[0,1]
    v_pk_mul_f32 v[196:197], v[196:197], v[36:37] neg_lo:[0,1] neg_hi:[0,1]
    v_pk_mul_f32 v[198:199], v[198:199], v[38:39] neg_lo:[0,1] neg_hi:[0,1]
    v_exp_f32 v192, v192
    v_exp_f32 v193, v193
    v_exp_f32 v194, v194
    v_exp_f32 v195, v195
    v_exp_f32 v196, v196
    v_exp_f32 v197, v197
    v_exp_f32 v198, v198
    v_exp_f32 v199, v199
    v_pk_fma_f32 v[192:193], v[192:193], s[62:63], s[62:63]
    v_pk_fma_f32 v[194:195], v[194:195], s[62:63], s[62:63]
    v_pk_fma_f32 v[196:197], v[196:197], s[62:63], s[62:63]
    v_pk_fma_f32 v[198:199], v[198:199], s[62:63], s[62:63]
    v_rcp_f32 v192, v192
    v_rcp_f32 v193, v193
    v_rcp_f32 v194, v194
    v_rcp_f32 v195, v195
    v_rcp_f32 v196, v196
    v_rcp_f32 v197, v197
    v_rcp_f32 v198, v198
    v_rcp_f32 v199, v199
    v_pk_mul_f32 v[32:33], v[32:33], v[192:193]
    v_pk_mul_f32 v[34:35], v[34:35], v[194:195]
    v_pk_mul_f32 v[36:37], v[36:37], v[196:197]
    v_pk_mul_f32 v[38:39], v[38:39], v[198:199]
    v_cvt_pk_bf16_f32 v176, v32, v33
    v_cvt_pk_bf16_f32 v177, v34, v35
    v_cvt_pk_bf16_f32 v178, v36, v37
    v_cvt_pk_bf16_f32 v179, v38, v39
    s_waitcnt vmcnt(2)
    buffer_store_dwordx4 v[176:179], v6, s[24:27], s48 offen offset:1024 sc1
    v_pk_fma_f32 v[216:217], v[232:233], v[166:167], v[240:241]
    v_pk_fma_f32 v[218:219], v[234:235], v[166:167], v[242:243]
    v_pk_fma_f32 v[220:221], v[236:237], v[166:167], v[244:245]
    v_pk_fma_f32 v[222:223], v[238:239], v[166:167], v[246:247]
    v_pk_fma_f32 v[68:69], v[68:69], v[164:165], v[216:217]
    v_pk_fma_f32 v[70:71], v[70:71], v[164:165], v[218:219]
    v_pk_fma_f32 v[72:73], v[72:73], v[164:165], v[220:221]
    v_pk_fma_f32 v[74:75], v[74:75], v[164:165], v[222:223]
    v_pk_fma_f32 v[216:217], v[68:69], v[68:69], v[8:9]
    v_pk_fma_f32 v[218:219], v[70:71], v[70:71], v[8:9]
    v_pk_fma_f32 v[220:221], v[72:73], v[72:73], v[8:9]
    v_pk_fma_f32 v[222:223], v[74:75], v[74:75], v[8:9]
    v_pk_mul_f32 v[216:217], v[216:217], v[68:69] neg_lo:[0,1] neg_hi:[0,1]
    v_pk_mul_f32 v[218:219], v[218:219], v[70:71] neg_lo:[0,1] neg_hi:[0,1]
    v_pk_mul_f32 v[220:221], v[220:221], v[72:73] neg_lo:[0,1] neg_hi:[0,1]
    v_pk_mul_f32 v[222:223], v[222:223], v[74:75] neg_lo:[0,1] neg_hi:[0,1]
    v_exp_f32 v216, v216
    v_exp_f32 v217, v217
    v_exp_f32 v218, v218
    v_exp_f32 v219, v219
    v_exp_f32 v220, v220
    v_exp_f32 v221, v221
    v_exp_f32 v222, v222
    v_exp_f32 v223, v223
    v_pk_fma_f32 v[216:217], v[216:217], s[62:63], s[62:63]
    v_pk_fma_f32 v[218:219], v[218:219], s[62:63], s[62:63]
    v_pk_fma_f32 v[220:221], v[220:221], s[62:63], s[62:63]
    v_pk_fma_f32 v[222:223], v[222:223], s[62:63], s[62:63]
    v_rcp_f32 v216, v216
    v_rcp_f32 v217, v217
    v_rcp_f32 v218, v218
    v_rcp_f32 v219, v219
    v_rcp_f32 v220, v220
    v_rcp_f32 v221, v221
    v_rcp_f32 v222, v222
    v_rcp_f32 v223, v223
    v_pk_mul_f32 v[68:69], v[68:69], v[216:217]
    v_pk_mul_f32 v[70:71], v[70:71], v[218:219]
    v_pk_mul_f32 v[72:73], v[72:73], v[220:221]
    v_pk_mul_f32 v[74:75], v[74:75], v[222:223]
    v_cvt_pk_bf16_f32 v180, v68, v69
    v_cvt_pk_bf16_f32 v181, v70, v71
    v_cvt_pk_bf16_f32 v182, v72, v73
    v_cvt_pk_bf16_f32 v183, v74, v75
    s_waitcnt vmcnt(2)
    buffer_store_dwordx4 v[180:183], v6, s[24:27], s49 offen offset:1024 sc1
    v_pk_fma_f32 v[192:193], v[232:233], v[170:171], v[240:241]
    v_pk_fma_f32 v[194:195], v[234:235], v[170:171], v[242:243]
    v_pk_fma_f32 v[196:197], v[236:237], v[170:171], v[244:245]
    v_pk_fma_f32 v[198:199], v[238:239], v[170:171], v[246:247]
    v_pk_fma_f32 v[104:105], v[104:105], v[168:169], v[192:193]
    v_pk_fma_f32 v[106:107], v[106:107], v[168:169], v[194:195]
    v_pk_fma_f32 v[108:109], v[108:109], v[168:169], v[196:197]
    v_pk_fma_f32 v[110:111], v[110:111], v[168:169], v[198:199]
    v_pk_fma_f32 v[192:193], v[104:105], v[104:105], v[8:9]
    v_pk_fma_f32 v[194:195], v[106:107], v[106:107], v[8:9]
    v_pk_fma_f32 v[196:197], v[108:109], v[108:109], v[8:9]
    v_pk_fma_f32 v[198:199], v[110:111], v[110:111], v[8:9]
    v_pk_mul_f32 v[192:193], v[192:193], v[104:105] neg_lo:[0,1] neg_hi:[0,1]
    v_pk_mul_f32 v[194:195], v[194:195], v[106:107] neg_lo:[0,1] neg_hi:[0,1]
    v_pk_mul_f32 v[196:197], v[196:197], v[108:109] neg_lo:[0,1] neg_hi:[0,1]
    v_pk_mul_f32 v[198:199], v[198:199], v[110:111] neg_lo:[0,1] neg_hi:[0,1]
    v_exp_f32 v192, v192
    v_exp_f32 v193, v193
    v_exp_f32 v194, v194
    v_exp_f32 v195, v195
    v_exp_f32 v196, v196
    v_exp_f32 v197, v197
    v_exp_f32 v198, v198
    v_exp_f32 v199, v199
    v_pk_fma_f32 v[192:193], v[192:193], s[62:63], s[62:63]
    v_pk_fma_f32 v[194:195], v[194:195], s[62:63], s[62:63]
    v_pk_fma_f32 v[196:197], v[196:197], s[62:63], s[62:63]
    v_pk_fma_f32 v[198:199], v[198:199], s[62:63], s[62:63]
    v_rcp_f32 v192, v192
    v_rcp_f32 v193, v193
    v_rcp_f32 v194, v194
    v_rcp_f32 v195, v195
    v_rcp_f32 v196, v196
    v_rcp_f32 v197, v197
    v_rcp_f32 v198, v198
    v_rcp_f32 v199, v199
    v_pk_mul_f32 v[104:105], v[104:105], v[192:193]
    v_pk_mul_f32 v[106:107], v[106:107], v[194:195]
    v_pk_mul_f32 v[108:109], v[108:109], v[196:197]
    v_pk_mul_f32 v[110:111], v[110:111], v[198:199]
    v_cvt_pk_bf16_f32 v184, v104, v105
    v_cvt_pk_bf16_f32 v185, v106, v107
    v_cvt_pk_bf16_f32 v186, v108, v109
    v_cvt_pk_bf16_f32 v187, v110, v111
    s_waitcnt vmcnt(2)
    buffer_store_dwordx4 v[184:187], v6, s[24:27], s50 offen offset:1024 sc1
    v_pk_fma_f32 v[216:217], v[232:233], v[174:175], v[240:241]
    v_pk_fma_f32 v[218:219], v[234:235], v[174:175], v[242:243]
    v_pk_fma_f32 v[220:221], v[236:237], v[174:175], v[244:245]
    v_pk_fma_f32 v[222:223], v[238:239], v[174:175], v[246:247]
    v_pk_fma_f32 v[140:141], v[140:141], v[172:173], v[216:217]
    v_pk_fma_f32 v[142:143], v[142:143], v[172:173], v[218:219]
    v_pk_fma_f32 v[144:145], v[144:145], v[172:173], v[220:221]
    v_pk_fma_f32 v[146:147], v[146:147], v[172:173], v[222:223]
    v_pk_fma_f32 v[216:217], v[140:141], v[140:141], v[8:9]
    v_pk_fma_f32 v[218:219], v[142:143], v[142:143], v[8:9]
    v_pk_fma_f32 v[220:221], v[144:145], v[144:145], v[8:9]
    v_pk_fma_f32 v[222:223], v[146:147], v[146:147], v[8:9]
    v_pk_mul_f32 v[216:217], v[216:217], v[140:141] neg_lo:[0,1] neg_hi:[0,1]
    v_pk_mul_f32 v[218:219], v[218:219], v[142:143] neg_lo:[0,1] neg_hi:[0,1]
    v_pk_mul_f32 v[220:221], v[220:221], v[144:145] neg_lo:[0,1] neg_hi:[0,1]
    v_pk_mul_f32 v[222:223], v[222:223], v[146:147] neg_lo:[0,1] neg_hi:[0,1]
    v_exp_f32 v216, v216
    v_exp_f32 v217, v217
    v_exp_f32 v218, v218
    v_exp_f32 v219, v219
    v_exp_f32 v220, v220
    v_exp_f32 v221, v221
    v_exp_f32 v222, v222
    v_exp_f32 v223, v223
    v_pk_fma_f32 v[216:217], v[216:217], s[62:63], s[62:63]
    v_pk_fma_f32 v[218:219], v[218:219], s[62:63], s[62:63]
    v_pk_fma_f32 v[220:221], v[220:221], s[62:63], s[62:63]
    v_pk_fma_f32 v[222:223], v[222:223], s[62:63], s[62:63]
    v_rcp_f32 v216, v216
    v_rcp_f32 v217, v217
    v_rcp_f32 v218, v218
    v_rcp_f32 v219, v219
    v_rcp_f32 v220, v220
    v_rcp_f32 v221, v221
    v_rcp_f32 v222, v222
    v_rcp_f32 v223, v223
    v_pk_mul_f32 v[140:141], v[140:141], v[216:217]
    v_pk_mul_f32 v[142:143], v[142:143], v[218:219]
    v_pk_mul_f32 v[144:145], v[144:145], v[220:221]
    v_pk_mul_f32 v[146:147], v[146:147], v[222:223]
    v_cvt_pk_bf16_f32 v188, v140, v141
    v_cvt_pk_bf16_f32 v189, v142, v143
    v_cvt_pk_bf16_f32 v190, v144, v145
    v_cvt_pk_bf16_f32 v191, v146, v147
    s_waitcnt vmcnt(2)
    buffer_store_dwordx4 v[188:191], v6, s[24:27], s51 offen offset:1024 sc1
    s_waitcnt lgkmcnt(0)
    ds_read_b128 v[232:235], v13 offset:640
    ds_read_b128 v[240:243], v13 offset:2048
    v_pk_fma_f32 v[192:193], v[200:201], v[162:163], v[208:209]
    v_pk_fma_f32 v[194:195], v[202:203], v[162:163], v[210:211]
    v_pk_fma_f32 v[196:197], v[204:205], v[162:163], v[212:213]
    v_pk_fma_f32 v[198:199], v[206:207], v[162:163], v[214:215]
    v_pk_fma_f32 v[40:41], v[40:41], v[160:161], v[192:193]
    v_pk_fma_f32 v[42:43], v[42:43], v[160:161], v[194:195]
    v_pk_fma_f32 v[44:45], v[44:45], v[160:161], v[196:197]
    v_pk_fma_f32 v[46:47], v[46:47], v[160:161], v[198:199]
    v_pk_fma_f32 v[192:193], v[40:41], v[40:41], v[8:9]
    v_pk_fma_f32 v[194:195], v[42:43], v[42:43], v[8:9]
    v_pk_fma_f32 v[196:197], v[44:45], v[44:45], v[8:9]
    v_pk_fma_f32 v[198:199], v[46:47], v[46:47], v[8:9]
    v_pk_mul_f32 v[192:193], v[192:193], v[40:41] neg_lo:[0,1] neg_hi:[0,1]
    v_pk_mul_f32 v[194:195], v[194:195], v[42:43] neg_lo:[0,1] neg_hi:[0,1]
    v_pk_mul_f32 v[196:197], v[196:197], v[44:45] neg_lo:[0,1] neg_hi:[0,1]
    v_pk_mul_f32 v[198:199], v[198:199], v[46:47] neg_lo:[0,1] neg_hi:[0,1]
    v_exp_f32 v192, v192
    v_exp_f32 v193, v193
    v_exp_f32 v194, v194
    v_exp_f32 v195, v195
    v_exp_f32 v196, v196
    v_exp_f32 v197, v197
    v_exp_f32 v198, v198
    v_exp_f32 v199, v199
    v_pk_fma_f32 v[192:193], v[192:193], s[62:63], s[62:63]
    v_pk_fma_f32 v[194:195], v[194:195], s[62:63], s[62:63]
    v_pk_fma_f32 v[196:197], v[196:197], s[62:63], s[62:63]
    v_pk_fma_f32 v[198:199], v[198:199], s[62:63], s[62:63]
    v_rcp_f32 v192, v192
    v_rcp_f32 v193, v193
    v_rcp_f32 v194, v194
    v_rcp_f32 v195, v195
    v_rcp_f32 v196, v196
    v_rcp_f32 v197, v197
    v_rcp_f32 v198, v198
    v_rcp_f32 v199, v199
    v_pk_mul_f32 v[40:41], v[40:41], v[192:193]
    v_pk_mul_f32 v[42:43], v[42:43], v[194:195]
    v_pk_mul_f32 v[44:45], v[44:45], v[196:197]
    v_pk_mul_f32 v[46:47], v[46:47], v[198:199]
    v_cvt_pk_bf16_f32 v176, v40, v41
    v_cvt_pk_bf16_f32 v177, v42, v43
    v_cvt_pk_bf16_f32 v178, v44, v45
    v_cvt_pk_bf16_f32 v179, v46, v47
    s_waitcnt vmcnt(2)
    buffer_store_dwordx4 v[176:179], v6, s[24:27], s48 offen offset:2048 sc1
    v_pk_fma_f32 v[216:217], v[200:201], v[166:167], v[208:209]
    v_pk_fma_f32 v[218:219], v[202:203], v[166:167], v[210:211]
    v_pk_fma_f32 v[220:221], v[204:205], v[166:167], v[212:213]
    v_pk_fma_f32 v[222:223], v[206:207], v[166:167], v[214:215]
    v_pk_fma_f32 v[76:77], v[76:77], v[164:165], v[216:217]
    v_pk_fma_f32 v[78:79], v[78:79], v[164:165], v[218:219]
    v_pk_fma_f32 v[80:81], v[80:81], v[164:165], v[220:221]
    v_pk_fma_f32 v[82:83], v[82:83], v[164:165], v[222:223]
    v_pk_fma_f32 v[216:217], v[76:77], v[76:77], v[8:9]
    v_pk_fma_f32 v[218:219], v[78:79], v[78:79], v[8:9]
    v_pk_fma_f32 v[220:221], v[80:81], v[80:81], v[8:9]
    v_pk_fma_f32 v[222:223], v[82:83], v[82:83], v[8:9]
    v_pk_mul_f32 v[216:217], v[216:217], v[76:77] neg_lo:[0,1] neg_hi:[0,1]
    v_pk_mul_f32 v[218:219], v[218:219], v[78:79] neg_lo:[0,1] neg_hi:[0,1]
    v_pk_mul_f32 v[220:221], v[220:221], v[80:81] neg_lo:[0,1] neg_hi:[0,1]
    v_pk_mul_f32 v[222:223], v[222:223], v[82:83] neg_lo:[0,1] neg_hi:[0,1]
    v_exp_f32 v216, v216
    v_exp_f32 v217, v217
    v_exp_f32 v218, v218
    v_exp_f32 v219, v219
    v_exp_f32 v220, v220
    v_exp_f32 v221, v221
    v_exp_f32 v222, v222
    v_exp_f32 v223, v223
    v_pk_fma_f32 v[216:217], v[216:217], s[62:63], s[62:63]
    v_pk_fma_f32 v[218:219], v[218:219], s[62:63], s[62:63]
    v_pk_fma_f32 v[220:221], v[220:221], s[62:63], s[62:63]
    v_pk_fma_f32 v[222:223], v[222:223], s[62:63], s[62:63]
    v_rcp_f32 v216, v216
    v_rcp_f32 v217, v217
    v_rcp_f32 v218, v218
    v_rcp_f32 v219, v219
    v_rcp_f32 v220, v220
    v_rcp_f32 v221, v221
    v_rcp_f32 v222, v222
    v_rcp_f32 v223, v223
    v_pk_mul_f32 v[76:77], v[76:77], v[216:217]
    v_pk_mul_f32 v[78:79], v[78:79], v[218:219]
    v_pk_mul_f32 v[80:81], v[80:81], v[220:221]
    v_pk_mul_f32 v[82:83], v[82:83], v[222:223]
    v_cvt_pk_bf16_f32 v180, v76, v77
    v_cvt_pk_bf16_f32 v181, v78, v79
    v_cvt_pk_bf16_f32 v182, v80, v81
    v_cvt_pk_bf16_f32 v183, v82, v83
    s_waitcnt vmcnt(2)
    buffer_store_dwordx4 v[180:183], v6, s[24:27], s49 offen offset:2048 sc1
    v_pk_fma_f32 v[192:193], v[200:201], v[170:171], v[208:209]
    v_pk_fma_f32 v[194:195], v[202:203], v[170:171], v[210:211]
    v_pk_fma_f32 v[196:197], v[204:205], v[170:171], v[212:213]
    v_pk_fma_f32 v[198:199], v[206:207], v[170:171], v[214:215]
    v_pk_fma_f32 v[112:113], v[112:113], v[168:169], v[192:193]
    v_pk_fma_f32 v[114:115], v[114:115], v[168:169], v[194:195]
    v_pk_fma_f32 v[116:117], v[116:117], v[168:169], v[196:197]
    v_pk_fma_f32 v[118:119], v[118:119], v[168:169], v[198:199]
    v_pk_fma_f32 v[192:193], v[112:113], v[112:113], v[8:9]
    v_pk_fma_f32 v[194:195], v[114:115], v[114:115], v[8:9]
    v_pk_fma_f32 v[196:197], v[116:117], v[116:117], v[8:9]
    v_pk_fma_f32 v[198:199], v[118:119], v[118:119], v[8:9]
    v_pk_mul_f32 v[192:193], v[192:193], v[112:113] neg_lo:[0,1] neg_hi:[0,1]
    v_pk_mul_f32 v[194:195], v[194:195], v[114:115] neg_lo:[0,1] neg_hi:[0,1]
    v_pk_mul_f32 v[196:197], v[196:197], v[116:117] neg_lo:[0,1] neg_hi:[0,1]
    v_pk_mul_f32 v[198:199], v[198:199], v[118:119] neg_lo:[0,1] neg_hi:[0,1]
    v_exp_f32 v192, v192
    v_exp_f32 v193, v193
    v_exp_f32 v194, v194
    v_exp_f32 v195, v195
    v_exp_f32 v196, v196
    v_exp_f32 v197, v197
    v_exp_f32 v198, v198
    v_exp_f32 v199, v199
    v_pk_fma_f32 v[192:193], v[192:193], s[62:63], s[62:63]
    v_pk_fma_f32 v[194:195], v[194:195], s[62:63], s[62:63]
    v_pk_fma_f32 v[196:197], v[196:197], s[62:63], s[62:63]
    v_pk_fma_f32 v[198:199], v[198:199], s[62:63], s[62:63]
    v_rcp_f32 v192, v192
    v_rcp_f32 v193, v193
    v_rcp_f32 v194, v194
    v_rcp_f32 v195, v195
    v_rcp_f32 v196, v196
    v_rcp_f32 v197, v197
    v_rcp_f32 v198, v198
    v_rcp_f32 v199, v199
    v_pk_mul_f32 v[112:113], v[112:113], v[192:193]
    v_pk_mul_f32 v[114:115], v[114:115], v[194:195]
    v_pk_mul_f32 v[116:117], v[116:117], v[196:197]
    v_pk_mul_f32 v[118:119], v[118:119], v[198:199]
    v_cvt_pk_bf16_f32 v184, v112, v113
    v_cvt_pk_bf16_f32 v185, v114, v115
    v_cvt_pk_bf16_f32 v186, v116, v117
    v_cvt_pk_bf16_f32 v187, v118, v119
    s_waitcnt vmcnt(2)
    buffer_store_dwordx4 v[184:187], v6, s[24:27], s50 offen offset:2048 sc1
    v_pk_fma_f32 v[216:217], v[200:201], v[174:175], v[208:209]
    v_pk_fma_f32 v[218:219], v[202:203], v[174:175], v[210:211]
    v_pk_fma_f32 v[220:221], v[204:205], v[174:175], v[212:213]
    v_pk_fma_f32 v[222:223], v[206:207], v[174:175], v[214:215]
    v_pk_fma_f32 v[148:149], v[148:149], v[172:173], v[216:217]
    v_pk_fma_f32 v[150:151], v[150:151], v[172:173], v[218:219]
    v_pk_fma_f32 v[152:153], v[152:153], v[172:173], v[220:221]
    v_pk_fma_f32 v[154:155], v[154:155], v[172:173], v[222:223]
    v_pk_fma_f32 v[216:217], v[148:149], v[148:149], v[8:9]
    v_pk_fma_f32 v[218:219], v[150:151], v[150:151], v[8:9]
    v_pk_fma_f32 v[220:221], v[152:153], v[152:153], v[8:9]
    v_pk_fma_f32 v[222:223], v[154:155], v[154:155], v[8:9]
    v_pk_mul_f32 v[216:217], v[216:217], v[148:149] neg_lo:[0,1] neg_hi:[0,1]
    v_pk_mul_f32 v[218:219], v[218:219], v[150:151] neg_lo:[0,1] neg_hi:[0,1]
    v_pk_mul_f32 v[220:221], v[220:221], v[152:153] neg_lo:[0,1] neg_hi:[0,1]
    v_pk_mul_f32 v[222:223], v[222:223], v[154:155] neg_lo:[0,1] neg_hi:[0,1]
    v_exp_f32 v216, v216
    v_exp_f32 v217, v217
    v_exp_f32 v218, v218
    v_exp_f32 v219, v219
    v_exp_f32 v220, v220
    v_exp_f32 v221, v221
    v_exp_f32 v222, v222
    v_exp_f32 v223, v223
    v_pk_fma_f32 v[216:217], v[216:217], s[62:63], s[62:63]
    v_pk_fma_f32 v[218:219], v[218:219], s[62:63], s[62:63]
    v_pk_fma_f32 v[220:221], v[220:221], s[62:63], s[62:63]
    v_pk_fma_f32 v[222:223], v[222:223], s[62:63], s[62:63]
    v_rcp_f32 v216, v216
    v_rcp_f32 v217, v217
    v_rcp_f32 v218, v218
    v_rcp_f32 v219, v219
    v_rcp_f32 v220, v220
    v_rcp_f32 v221, v221
    v_rcp_f32 v222, v222
    v_rcp_f32 v223, v223
    v_pk_mul_f32 v[148:149], v[148:149], v[216:217]
    v_pk_mul_f32 v[150:151], v[150:151], v[218:219]
    v_pk_mul_f32 v[152:153], v[152:153], v[220:221]
    v_pk_mul_f32 v[154:155], v[154:155], v[222:223]
    v_cvt_pk_bf16_f32 v188, v148, v149
    v_cvt_pk_bf16_f32 v189, v150, v151
    v_cvt_pk_bf16_f32 v190, v152, v153
    v_cvt_pk_bf16_f32 v191, v154, v155
    s_waitcnt vmcnt(2)
    buffer_store_dwordx4 v[188:191], v6, s[24:27], s51 offen offset:2048 sc1
    s_waitcnt lgkmcnt(0)
    v_pk_fma_f32 v[192:193], v[232:233], v[162:163], v[240:241]
    v_pk_fma_f32 v[194:195], v[234:235], v[162:163], v[242:243]
    v_pk_fma_f32 v[196:197], v[232:233], v[166:167], v[240:241]
    v_pk_fma_f32 v[198:199], v[234:235], v[166:167], v[242:243]
    v_pk_fma_f32 v[48:49], v[48:49], v[160:161], v[192:193]
    v_pk_fma_f32 v[50:51], v[50:51], v[160:161], v[194:195]
    v_pk_fma_f32 v[84:85], v[84:85], v[164:165], v[196:197]
    v_pk_fma_f32 v[86:87], v[86:87], v[164:165], v[198:199]
    v_pk_fma_f32 v[192:193], v[48:49], v[48:49], v[8:9]
    v_pk_fma_f32 v[194:195], v[50:51], v[50:51], v[8:9]
    v_pk_fma_f32 v[196:197], v[84:85], v[84:85], v[8:9]
    v_pk_fma_f32 v[198:199], v[86:87], v[86:87], v[8:9]
    v_pk_mul_f32 v[192:193], v[192:193], v[48:49] neg_lo:[0,1] neg_hi:[0,1]
    v_pk_mul_f32 v[194:195], v[194:195], v[50:51] neg_lo:[0,1] neg_hi:[0,1]
    v_pk_mul_f32 v[196:197], v[196:197], v[84:85] neg_lo:[0,1] neg_hi:[0,1]
    v_pk_mul_f32 v[198:199], v[198:199], v[86:87] neg_lo:[0,1] neg_hi:[0,1]
    v_exp_f32 v192, v192
    v_exp_f32 v193, v193
    v_exp_f32 v194, v194
    v_exp_f32 v195, v195
    v_exp_f32 v196, v196
    v_exp_f32 v197, v197
    v_exp_f32 v198, v198
    v_exp_f32 v199, v199
    v_pk_fma_f32 v[192:193], v[192:193], s[62:63], s[62:63]
    v_pk_fma_f32 v[194:195], v[194:195], s[62:63], s[62:63]
    v_pk_fma_f32 v[196:197], v[196:197], s[62:63], s[62:63]
    v_pk_fma_f32 v[198:199], v[198:199], s[62:63], s[62:63]
    v_rcp_f32 v192, v192
    v_rcp_f32 v193, v193
    v_rcp_f32 v194, v194
    v_rcp_f32 v195, v195
    v_rcp_f32 v196, v196
    v_rcp_f32 v197, v197
    v_rcp_f32 v198, v198
    v_rcp_f32 v199, v199
    v_pk_mul_f32 v[48:49], v[48:49], v[192:193]
    v_pk_mul_f32 v[50:51], v[50:51], v[194:195]
    v_pk_mul_f32 v[84:85], v[84:85], v[196:197]
    v_pk_mul_f32 v[86:87], v[86:87], v[198:199]
    v_cvt_pk_bf16_f32 v176, v48, v49
    v_cvt_pk_bf16_f32 v177, v50, v51
    v_cvt_pk_bf16_f32 v178, v84, v85
    v_cvt_pk_bf16_f32 v179, v86, v87
    buffer_store_dwordx2 v[176:177], v7, s[24:27], s48 offen offset:3072 sc1
    buffer_store_dwordx2 v[178:179], v7, s[24:27], s49 offen offset:3072 sc1
    v_pk_fma_f32 v[216:217], v[232:233], v[170:171], v[240:241]
    v_pk_fma_f32 v[218:219], v[234:235], v[170:171], v[242:243]
    v_pk_fma_f32 v[220:221], v[232:233], v[174:175], v[240:241]
    v_pk_fma_f32 v[222:223], v[234:235], v[174:175], v[242:243]
    v_pk_fma_f32 v[120:121], v[120:121], v[168:169], v[216:217]
    v_pk_fma_f32 v[122:123], v[122:123], v[168:169], v[218:219]
    v_pk_fma_f32 v[156:157], v[156:157], v[172:173], v[220:221]
    v_pk_fma_f32 v[158:159], v[158:159], v[172:173], v[222:223]
    v_pk_fma_f32 v[216:217], v[120:121], v[120:121], v[8:9]
    v_pk_fma_f32 v[218:219], v[122:123], v[122:123], v[8:9]
    v_pk_fma_f32 v[220:221], v[156:157], v[156:157], v[8:9]
    v_pk_fma_f32 v[222:223], v[158:159], v[158:159], v[8:9]
    v_pk_mul_f32 v[216:217], v[216:217], v[120:121] neg_lo:[0,1] neg_hi:[0,1]
    v_pk_mul_f32 v[218:219], v[218:219], v[122:123] neg_lo:[0,1] neg_hi:[0,1]
    v_pk_mul_f32 v[220:221], v[220:221], v[156:157] neg_lo:[0,1] neg_hi:[0,1]
    v_pk_mul_f32 v[222:223], v[222:223], v[158:159] neg_lo:[0,1] neg_hi:[0,1]
    v_exp_f32 v216, v216
    v_exp_f32 v217, v217
    v_exp_f32 v218, v218
    v_exp_f32 v219, v219
    v_exp_f32 v220, v220
    v_exp_f32 v221, v221
    v_exp_f32 v222, v222
    v_exp_f32 v223, v223
    v_pk_fma_f32 v[216:217], v[216:217], s[62:63], s[62:63]
    v_pk_fma_f32 v[218:219], v[218:219], s[62:63], s[62:63]
    v_pk_fma_f32 v[220:221], v[220:221], s[62:63], s[62:63]
    v_pk_fma_f32 v[222:223], v[222:223], s[62:63], s[62:63]
    v_rcp_f32 v216, v216
    v_rcp_f32 v217, v217
    v_rcp_f32 v218, v218
    v_rcp_f32 v219, v219
    v_rcp_f32 v220, v220
    v_rcp_f32 v221, v221
    v_rcp_f32 v222, v222
    v_rcp_f32 v223, v223
    v_pk_mul_f32 v[120:121], v[120:121], v[216:217]
    v_pk_mul_f32 v[122:123], v[122:123], v[218:219]
    v_pk_mul_f32 v[156:157], v[156:157], v[220:221]
    v_pk_mul_f32 v[158:159], v[158:159], v[222:223]
    v_cvt_pk_bf16_f32 v180, v120, v121
    v_cvt_pk_bf16_f32 v181, v122, v123
    v_cvt_pk_bf16_f32 v182, v156, v157
    v_cvt_pk_bf16_f32 v183, v158, v159
    buffer_store_dwordx2 v[180:181], v7, s[24:27], s50 offen offset:3072 sc1
    buffer_store_dwordx2 v[182:183], v7, s[24:27], s51 offen offset:3072 sc1
    s_lshl_b32 s37, s41, 5
    s_lshr_b32 s38, s42, 3
    s_lshl_b32 s38, s38, 1
    s_add_u32 s37, s37, s38
    s_add_u32 s37, s37, s44
    s_lshl_b32 s37, s37, 7
    s_and_b32 s38, s42, 7
    s_lshl_b32 s38, s38, 1
    s_add_u32 s38, s38, s45
    s_lshl_b32 s38, s38, 2
    s_add_u32 s37, s37, s38
    s_add_u32 s37, s37, 0x2e00a00
    s_and_b32 s41, s2, 3
    s_lshl_b32 s41, s41, 2
    s_bfe_u32 s43, s2, 0x20003
    s_add_u32 s41, s41, s43
    s_bfe_u32 s44, s2, 0x10002
    s_lshr_b32 s42, s2, 5
    v_and_b32 v13, 3, v1
    v_lshlrev_b32 v13, 4, v13
    s_lshl_b32 s47, s44, 1
    v_xor_b32 v14, s47, v4
    v_lshl_add_u32 v13, v14, 6, v13
    v_bfe_u32 v14, v1, 2, 2
    v_lshl_add_u32 v8, v14, 11, v13
    s_lshl_b32 s47, s40, 16
    v_add_u32 v8, s47, v8
    v_xor_b32 v9, 32, v8
    s_lshl_b32 s52, s40, 13
    s_add_u32 s52, s52, 61440
    s_mul_i32 s54, s44, 3670016
    s_lshl_b32 s48, s42, 8
    s_add_u32 s54, s54, s48
    s_mul_i32 s53, s44, 57344
    s_add_u32 s53, s53, 0x8000
    s_cmp_eq_u32 s44, 0
    s_mov_b32 s58, 0
    s_cselect_b32 s58, 0, s58
    s_mov_b32 s60, 32768
    s_cselect_b32 s60, 32768, s60
    s_mov_b32 s61, 65536
    s_cselect_b32 s61, 65536, s61
    s_cselect_b32 s59, 3, 3
    s_add_u32 s56, s52, s58
    s_movk_i32 s57, 0x2000
    s_mov_b32 s16, s8
    s_and_b32 s17, s9, 0xffff
    s_mov_b32 s18, 0x700000
    s_mov_b32 s19, 0x20000
    s_add_u32 s20, s6, 0x1000000
    s_addc_u32 s21, s7, 0
    s_and_b32 s21, s21, 0xffff
    s_mov_b32 s22, 0x1200000
    s_mov_b32 s23, 0x20000
    s_lshl_b32 s46, s41, 3
    s_lshl_b32 s47, s40, 1
    s_add_u32 s46, s46, s47
    s_mul_i32 s47, s46, 147456
    v_add_u32 v6, s47, v5
    v_add_u32 v7, 147456, v6
    s_and_b32 s5, s5, 0xffff
    v_lshlrev_b32 v12, 9, v4
    v_add_u32 v12, v12, v15
    v_add_u32 v12, 61440, v12
    v_add_u32 v12, s58, v12
    v_xor_b32 v13, 32, v12
    v_mov_b32 v242, v15
    s_lshl_b32 s45, s44, 7
    s_add_u32 s45, s45, s48
    s_lshl_b32 s62, s40, 17
    v_lshrrev_b32 v10, 5, v1
    v_lshlrev_b32 v243, 1, v10
    v_and_b32 v14, 3, v1
    v_xor_b32 v243, v243, v14
    v_lshlrev_b32 v243, 4, v243
    v_bfe_u32 v14, v1, 4, 1
    v_lshl_add_u32 v243, v14, 6, v243
    v_bfe_u32 v14, v1, 2, 2
    v_lshl_add_u32 v10, v10, 2, v14
    v_lshl_add_u32 v10, v10, 11, v243
    v_add_u32 v10, s45, v10
    s_mov_b32 s64, s32
    s_and_b32 s65, s33, 0xffff
    s_mov_b32 s66, 0x400000
    s_mov_b32 s67, 0x20000
    s_mov_b32 s28, s34
    s_mov_b32 s29, s35
    s_mov_b32 s32, s10
    s_and_b32 s33, s11, 0xffff
    s_mov_b32 s34, 0x800
    s_mov_b32 s35, 0x20000
    v_and_b32 v15, 7, v1
    v_lshlrev_b32 v15, 4, v15
    v_lshrrev_b32 v14, 3, v1
    v_lshl_add_u32 v14, v14, 11, v15
    s_lshl_b32 s31, s46, 15
    s_add_u32 s31, s31, s45
    v_mov_b64 v[16:17], 0
    v_mov_b64 v[18:19], 0
    v_mov_b64 v[20:21], 0
    v_mov_b64 v[22:23], 0
    v_mov_b64 v[24:25], 0
    v_mov_b64 v[26:27], 0
    v_mov_b64 v[28:29], 0
    v_mov_b64 v[30:31], 0
    v_mov_b64 v[32:33], 0
    v_mov_b64 v[34:35], 0
    v_mov_b64 v[36:37], 0
    v_mov_b64 v[38:39], 0
    v_mov_b64 v[40:41], 0
    v_mov_b64 v[42:43], 0
    v_mov_b64 v[44:45], 0
    v_mov_b64 v[46:47], 0
    v_mov_b64 v[48:49], 0
    v_mov_b64 v[50:51], 0
    v_mov_b64 v[52:53], 0
    v_mov_b64 v[54:55], 0
    v_mov_b64 v[56:57], 0
    v_mov_b64 v[58:59], 0
    v_mov_b64 v[60:61], 0
    v_mov_b64 v[62:63], 0
    v_mov_b64 v[64:65], 0
    v_mov_b64 v[66:67], 0
    v_mov_b64 v[68:69], 0
    v_mov_b64 v[70:71], 0
    v_mov_b64 v[72:73], 0
    v_mov_b64 v[74:75], 0
    v_mov_b64 v[76:77], 0
    v_mov_b64 v[78:79], 0
    v_mov_b32 v240, 1
    v_mov_b32 v244, 0
    v_lshlrev_b32 v245, 2, v3
    s_lshl_b32 s36, s41, 5
    s_add_u32 s36, s36, s40
    s_lshl_b32 s36, s36, 7
    s_add_u32 s36, s36, 0x2e00800
    s_lshl_b32 s38, s41, 5
    s_lshl_b32 s39, s44, 1
    s_add_u32 s38, s38, s39
    v_mov_b32 v247, v245
    s_lshr_b32 s39, s40, 1
    s_add_u32 s38, s38, s39
    s_lshl_b32 s38, s38, 7
    s_add_u32 s38, s38, 0x2e00a00
    s_waitcnt vmcnt(0)
    s_mov_b64 exec, 1
    buffer_store_dword v11, v244, s[24:27], s37 offen sc1
    s_mov_b64 exec, -1
    s_mov_b32 s3, 0
LG_w1:
    ds_read_b32 v241, v255 offset:48
    s_add_u32 s3, s3, 1
    s_waitcnt lgkmcnt(0)
    v_cmp_gt_u32 vcc, 1, v241
    s_nop 4
    s_cbranch_vccz LG_w1_ok
    s_sleep 1
    s_cmp_lt_u32 s3, 8000000
    s_cbranch_scc1 LG_w1
LG_w1_ok:
    s_add_u32 m0, s56, 0
    s_mov_b32 s55, s54
    buffer_load_dwordx4 v8, s[16:19], s55 offen lds
    s_add_u32 m0, s56, 1024
    s_add_u32 s55, s55, s57
    buffer_load_dwordx4 v9, s[16:19], s55 offen lds
    s_add_u32 m0, s56, 2048
    s_add_u32 s55, s55, s57
    buffer_load_dwordx4 v8, s[16:19], s55 offen lds
    s_add_u32 m0, s56, 3072
    s_add_u32 s55, s55, s57
    buffer_load_dwordx4 v9, s[16:19], s55 offen lds
    s_add_u32 m0, s56, 4096
    s_add_u32 s55, s55, s57
    buffer_load_dwordx4 v8, s[16:19], s55 offen lds
    s_add_u32 m0, s56, 5120
    s_add_u32 s55, s55, s57
    buffer_load_dwordx4 v9, s[16:19], s55 offen lds
    s_add_u32 m0, s56, 6144
    s_add_u32 s55, s55, s57
    buffer_load_dwordx4 v8, s[16:19], s55 offen lds
    s_add_u32 m0, s56, 7168
    s_add_u32 s55, s55, s57
    buffer_load_dwordx4 v9, s[16:19], s55 offen lds
    s_add_u32 s54, s54, 0x40000
    s_add_u32 s56, s52, s60
    s_add_u32 m0, s56, 0
    s_mov_b32 s55, s54
    buffer_load_dwordx4 v8, s[16:19], s55 offen lds
    s_add_u32 m0, s56, 1024
    s_add_u32 s55, s55, s57
    buffer_load_dwordx4 v9, s[16:19], s55 offen lds
    s_add_u32 m0, s56, 2048
    s_add_u32 s55, s55, s57
    buffer_load_dwordx4 v8, s[16:19], s55 offen lds
    s_add_u32 m0, s56, 3072
    s_add_u32 s55, s55, s57
    buffer_load_dwordx4 v9, s[16:19], s55 offen lds
    s_add_u32 m0, s56, 4096
    s_add_u32 s55, s55, s57
    buffer_load_dwordx4 v8, s[16:19], s55 offen lds
    s_add_u32 m0, s56, 5120
    s_add_u32 s55, s55, s57
    buffer_load_dwordx4 v9, s[16:19], s55 offen lds
    s_add_u32 m0, s56, 6144
    s_add_u32 s55, s55, s57
    buffer_load_dwordx4 v8, s[16:19], s55 offen lds
    s_add_u32 m0, s56, 7168
    s_add_u32 s55, s55, s57
    buffer_load_dwordx4 v9, s[16:19], s55 offen lds
    s_add_u32 s54, s54, 0x40000
    s_add_u32 s56, s52, s61
    s_mov_b32 s39, 0
LG_p1:
    buffer_load_dword v246, v247, s[24:27], s38 offen sc1
    s_add_u32 s39, s39, 1
    s_waitcnt vmcnt(0)
    v_cmp_ne_u32 vcc, 1, v246
    s_nop 4
    s_cbranch_vccz LG_p1_ok
    s_sleep 4
    s_cmp_lt_u32 s39, 1000000
    s_cbranch_scc1 LG_p1
LG_p1_ok:
    ds_write_b32 v254, v240 offset:64
    buffer_load_dwordx4 v[80:83], v6, s[20:23], s53 offen offset:0 sc1
    buffer_load_dwordx4 v[84:87], v7, s[20:23], s53 offen offset:0 sc1
    buffer_load_dwordx4 v[88:91], v6, s[20:23], s53 offen offset:1024 sc1
    buffer_load_dwordx4 v[92:95], v7, s[20:23], s53 offen offset:1024 sc1
    buffer_load_dwordx4 v[96:99], v6, s[20:23], s53 offen offset:2048 sc1
    buffer_load_dwordx4 v[100:103], v7, s[20:23], s53 offen offset:2048 sc1
    buffer_load_dwordx4 v[104:107], v6, s[20:23], s53 offen offset:3072 sc1
    buffer_load_dwordx4 v[108:111], v7, s[20:23], s53 offen offset:3072 sc1
    s_add_u32 s53, s53, 0x1000
    buffer_load_dwordx4 v[112:115], v6, s[20:23], s53 offen offset:0 sc1
    buffer_load_dwordx4 v[116:119], v7, s[20:23], s53 offen offset:0 sc1
    buffer_load_dwordx4 v[120:123], v6, s[20:23], s53 offen offset:1024 sc1
    buffer_load_dwordx4 v[124:127], v7, s[20:23], s53 offen offset:1024 sc1
    buffer_load_dwordx4 v[128:131], v6, s[20:23], s53 offen offset:2048 sc1
    buffer_load_dwordx4 v[132:135], v7, s[20:23], s53 offen offset:2048 sc1
    buffer_load_dwordx4 v[136:139], v6, s[20:23], s53 offen offset:3072 sc1
    buffer_load_dwordx4 v[140:143], v7, s[20:23], s53 offen offset:3072 sc1
    s_add_u32 s53, s53, 0x1000
    s_mov_b32 s3, 0
LG_w2:
    ds_read_b32 v241, v255 offset:64
    s_add_u32 s3, s3, 1
    s_waitcnt lgkmcnt(0)
    v_cmp_gt_u32 vcc, 1, v241
    s_nop 4
    s_cbranch_vccz LG_w2_ok
    s_sleep 1
    s_cmp_lt_u32 s3, 8000000
    s_cbranch_scc1 LG_w2
LG_w2_ok:
    ds_read_b64_tr_b16 v[144:145], v12 offset:0
    ds_read_b64_tr_b16 v[146:147], v12 offset:4096
    ds_read_b64_tr_b16 v[148:149], v13 offset:0
    ds_read_b64_tr_b16 v[150:151], v13 offset:4096
    ds_read_b64_tr_b16 v[152:153], v12 offset:256
    ds_read_b64_tr_b16 v[154:155], v12 offset:4352
    ds_read_b64_tr_b16 v[156:157], v13 offset:256
    ds_read_b64_tr_b16 v[158:159], v13 offset:4352
    ds_read_b64_tr_b16 v[160:161], v12 offset:512
    ds_read_b64_tr_b16 v[162:163], v12 offset:4608
    ds_read_b64_tr_b16 v[164:165], v13 offset:512
    ds_read_b64_tr_b16 v[166:167], v13 offset:4608
    ds_read_b64_tr_b16 v[168:169], v12 offset:768
    ds_read_b64_tr_b16 v[170:171], v12 offset:4864
    ds_read_b64_tr_b16 v[172:173], v13 offset:768
    ds_read_b64_tr_b16 v[174:175], v13 offset:4864
    s_mov_b32 s63, s58
    s_waitcnt vmcnt(0)
    s_setprio 0
    .p2align 6
LG_l2:
    s_waitcnt vmcnt(28) lgkmcnt(0)
    v_mfma_f32_16x16x32_bf16 v[16:19], v[144:147], v[80:83], v[16:19]
    ds_read_b64_tr_b16 v[176:177], v12 offset:8192
    ds_read_b64_tr_b16 v[178:179], v12 offset:12288
    v_mfma_f32_16x16x32_bf16 v[48:51], v[144:147], v[84:87], v[48:51]
    ds_read_b64_tr_b16 v[180:181], v13 offset:8192
    ds_read_b64_tr_b16 v[182:183], v13 offset:12288
    v_mfma_f32_16x16x32_bf16 v[20:23], v[148:151], v[80:83], v[20:23]
    ds_read_b64_tr_b16 v[184:185], v12 offset:8448
    ds_read_b64_tr_b16 v[186:187], v12 offset:12544
    v_mfma_f32_16x16x32_bf16 v[52:55], v[148:151], v[84:87], v[52:55]
    ds_read_b64_tr_b16 v[188:189], v13 offset:8448
    ds_read_b64_tr_b16 v[190:191], v13 offset:12544
    v_mfma_f32_16x16x32_bf16 v[24:27], v[152:155], v[80:83], v[24:27]
    ds_read_b64_tr_b16 v[192:193], v12 offset:8704
    ds_read_b64_tr_b16 v[194:195], v12 offset:12800
    v_mfma_f32_16x16x32_bf16 v[56:59], v[152:155], v[84:87], v[56:59]
    ds_read_b64_tr_b16 v[196:197], v13 offset:8704
    ds_read_b64_tr_b16 v[198:199], v13 offset:12800
    v_mfma_f32_16x16x32_bf16 v[28:31], v[156:159], v[80:83], v[28:31]
    ds_read_b64_tr_b16 v[200:201], v12 offset:8960
    ds_read_b64_tr_b16 v[202:203], v12 offset:13056
    v_mfma_f32_16x16x32_bf16 v[60:63], v[156:159], v[84:87], v[60:63]
    ds_read_b64_tr_b16 v[204:205], v13 offset:8960
    ds_read_b64_tr_b16 v[206:207], v13 offset:13056
    v_mfma_f32_16x16x32_bf16 v[32:35], v[160:163], v[80:83], v[32:35]
    s_add_u32 m0, s56, 0
    s_mov_b32 s55, s54
    v_mfma_f32_16x16x32_bf16 v[64:67], v[160:163], v[84:87], v[64:67]
    buffer_load_dwordx4 v8, s[16:19], s55 offen lds
    v_mfma_f32_16x16x32_bf16 v[36:39], v[164:167], v[80:83], v[36:39]
    s_add_u32 m0, s56, 1024
    s_add_u32 s55, s55, s57
    v_mfma_f32_16x16x32_bf16 v[68:71], v[164:167], v[84:87], v[68:71]
    buffer_load_dwordx4 v9, s[16:19], s55 offen lds
    v_mfma_f32_16x16x32_bf16 v[40:43], v[168:171], v[80:83], v[40:43]
    v_mfma_f32_16x16x32_bf16 v[72:75], v[168:171], v[84:87], v[72:75]
    v_mfma_f32_16x16x32_bf16 v[44:47], v[172:175], v[80:83], v[44:47]
    v_mfma_f32_16x16x32_bf16 v[76:79], v[172:175], v[84:87], v[76:79]
    buffer_load_dwordx4 v[80:83], v6, s[20:23], s53 offen offset:0 sc1
    buffer_load_dwordx4 v[84:87], v7, s[20:23], s53 offen offset:0 sc1
    s_waitcnt vmcnt(28) lgkmcnt(0)
    v_mfma_f32_16x16x32_bf16 v[16:19], v[176:179], v[88:91], v[16:19]
    ds_read_b64_tr_b16 v[144:145], v12 offset:16384
    ds_read_b64_tr_b16 v[146:147], v12 offset:20480
    v_mfma_f32_16x16x32_bf16 v[48:51], v[176:179], v[92:95], v[48:51]
    ds_read_b64_tr_b16 v[148:149], v13 offset:16384
    ds_read_b64_tr_b16 v[150:151], v13 offset:20480
    v_mfma_f32_16x16x32_bf16 v[20:23], v[180:183], v[88:91], v[20:23]
    ds_read_b64_tr_b16 v[152:153], v12 offset:16640
    ds_read_b64_tr_b16 v[154:155], v12 offset:20736
    v_mfma_f32_16x16x32_bf16 v[52:55], v[180:183], v[92:95], v[52:55]
    ds_read_b64_tr_b16 v[156:157], v13 offset:16640
    ds_read_b64_tr_b16 v[158:159], v13 offset:20736
    v_mfma_f32_16x16x32_bf16 v[24:27], v[184:187], v[88:91], v[24:27]
    ds_read_b64_tr_b16 v[160:161], v12 offset:16896
    ds_read_b64_tr_b16 v[162:163], v12 offset:20992
    v_mfma_f32_16x16x32_bf16 v[56:59], v[184:187], v[92:95], v[56:59]
    ds_read_b64_tr_b16 v[164:165], v13 offset:16896
    ds_read_b64_tr_b16 v[166:167], v13 offset:20992
    v_mfma_f32_16x16x32_bf16 v[28:31], v[188:191], v[88:91], v[28:31]
    ds_read_b64_tr_b16 v[168:169], v12 offset:17152
    ds_read_b64_tr_b16 v[170:171], v12 offset:21248
    v_mfma_f32_16x16x32_bf16 v[60:63], v[188:191], v[92:95], v[60:63]
    ds_read_b64_tr_b16 v[172:173], v13 offset:17152
    ds_read_b64_tr_b16 v[174:175], v13 offset:21248
    v_mfma_f32_16x16x32_bf16 v[32:35], v[192:195], v[88:91], v[32:35]
    s_add_u32 m0, s56, 2048
    s_add_u32 s55, s55, s57
    v_mfma_f32_16x16x32_bf16 v[64:67], v[192:195], v[92:95], v[64:67]
    buffer_load_dwordx4 v8, s[16:19], s55 offen lds
    v_mfma_f32_16x16x32_bf16 v[36:39], v[196:199], v[88:91], v[36:39]
    s_add_u32 m0, s56, 3072
    s_add_u32 s55, s55, s57
    v_mfma_f32_16x16x32_bf16 v[68:71], v[196:199], v[92:95], v[68:71]
    buffer_load_dwordx4 v9, s[16:19], s55 offen lds
    v_mfma_f32_16x16x32_bf16 v[40:43], v[200:203], v[88:91], v[40:43]
    v_mfma_f32_16x16x32_bf16 v[72:75], v[200:203], v[92:95], v[72:75]
    v_mfma_f32_16x16x32_bf16 v[44:47], v[204:207], v[88:91], v[44:47]
    v_mfma_f32_16x16x32_bf16 v[76:79], v[204:207], v[92:95], v[76:79]
    buffer_load_dwordx4 v[88:91], v6, s[20:23], s53 offen offset:1024 sc1
    buffer_load_dwordx4 v[92:95], v7, s[20:23], s53 offen offset:1024 sc1
    s_waitcnt vmcnt(28) lgkmcnt(0)
    v_mfma_f32_16x16x32_bf16 v[16:19], v[144:147], v[96:99], v[16:19]
    ds_read_b64_tr_b16 v[176:177], v12 offset:24576
    ds_read_b64_tr_b16 v[178:179], v12 offset:28672
    v_mfma_f32_16x16x32_bf16 v[48:51], v[144:147], v[100:103], v[48:51]
    ds_read_b64_tr_b16 v[180:181], v13 offset:24576
    ds_read_b64_tr_b16 v[182:183], v13 offset:28672
    v_mfma_f32_16x16x32_bf16 v[20:23], v[148:151], v[96:99], v[20:23]
    ds_read_b64_tr_b16 v[184:185], v12 offset:24832
    ds_read_b64_tr_b16 v[186:187], v12 offset:28928
    v_mfma_f32_16x16x32_bf16 v[52:55], v[148:151], v[100:103], v[52:55]
    ds_read_b64_tr_b16 v[188:189], v13 offset:24832
    ds_read_b64_tr_b16 v[190:191], v13 offset:28928
    v_mfma_f32_16x16x32_bf16 v[24:27], v[152:155], v[96:99], v[24:27]
    ds_read_b64_tr_b16 v[192:193], v12 offset:25088
    ds_read_b64_tr_b16 v[194:195], v12 offset:29184
    v_mfma_f32_16x16x32_bf16 v[56:59], v[152:155], v[100:103], v[56:59]
    ds_read_b64_tr_b16 v[196:197], v13 offset:25088
    ds_read_b64_tr_b16 v[198:199], v13 offset:29184
    v_mfma_f32_16x16x32_bf16 v[28:31], v[156:159], v[96:99], v[28:31]
    ds_read_b64_tr_b16 v[200:201], v12 offset:25344
    ds_read_b64_tr_b16 v[202:203], v12 offset:29440
    v_mfma_f32_16x16x32_bf16 v[60:63], v[156:159], v[100:103], v[60:63]
    ds_read_b64_tr_b16 v[204:205], v13 offset:25344
    ds_read_b64_tr_b16 v[206:207], v13 offset:29440
    v_mfma_f32_16x16x32_bf16 v[32:35], v[160:163], v[96:99], v[32:35]
    s_add_u32 m0, s56, 4096
    s_add_u32 s55, s55, s57
    v_mfma_f32_16x16x32_bf16 v[64:67], v[160:163], v[100:103], v[64:67]
    buffer_load_dwordx4 v8, s[16:19], s55 offen lds
    v_mfma_f32_16x16x32_bf16 v[36:39], v[164:167], v[96:99], v[36:39]
    s_add_u32 m0, s56, 5120
    s_add_u32 s55, s55, s57
    v_mfma_f32_16x16x32_bf16 v[68:71], v[164:167], v[100:103], v[68:71]
    buffer_load_dwordx4 v9, s[16:19], s55 offen lds
    v_mfma_f32_16x16x32_bf16 v[40:43], v[168:171], v[96:99], v[40:43]
    s_add_u32 s60, s58, 32768
    s_cmp_eq_u32 s60, 98304
    s_cselect_b32 s60, 0, s60
    v_mfma_f32_16x16x32_bf16 v[72:75], v[168:171], v[100:103], v[72:75]
    s_sub_u32 s61, s60, s58
    s_mov_b32 s58, s60
    v_mfma_f32_16x16x32_bf16 v[44:47], v[172:175], v[96:99], v[44:47]
    s_setprio 2
    v_add_u32 v12, s61, v12
    v_add_u32 v13, s61, v13
    v_add_u32 v240, 1, v240
    s_setprio 0
    v_mfma_f32_16x16x32_bf16 v[76:79], v[172:175], v[100:103], v[76:79]
    buffer_load_dwordx4 v[96:99], v6, s[20:23], s53 offen offset:2048 sc1
    buffer_load_dwordx4 v[100:103], v7, s[20:23], s53 offen offset:2048 sc1
    s_waitcnt vmcnt(14) lgkmcnt(0)
    ds_write_b32 v254, v240 offset:64
    v_mfma_f32_16x16x32_bf16 v[16:19], v[176:179], v[104:107], v[16:19]
    s_add_u32 m0, s56, 6144
    s_add_u32 s55, s55, s57
    v_mfma_f32_16x16x32_bf16 v[48:51], v[176:179], v[108:111], v[48:51]
    buffer_load_dwordx4 v8, s[16:19], s55 offen lds
    v_mfma_f32_16x16x32_bf16 v[20:23], v[180:183], v[104:107], v[20:23]
    ds_read_b32 v241, v255 offset:64
    v_mfma_f32_16x16x32_bf16 v[52:55], v[180:183], v[108:111], v[52:55]
    s_add_u32 m0, s56, 7168
    s_add_u32 s55, s55, s57
    v_mfma_f32_16x16x32_bf16 v[24:27], v[184:187], v[104:107], v[24:27]
    buffer_load_dwordx4 v9, s[16:19], s55 offen lds
    v_mfma_f32_16x16x32_bf16 v[56:59], v[184:187], v[108:111], v[56:59]
    s_add_u32 s54, s54, 0x40000
    s_add_u32 s56, s52, s63
    v_mfma_f32_16x16x32_bf16 v[28:31], v[188:191], v[104:107], v[28:31]
    s_waitcnt lgkmcnt(0)
    s_setprio 2
    v_cmp_gt_u32 vcc, v240, v241
    s_setprio 0
    v_mfma_f32_16x16x32_bf16 v[60:63], v[188:191], v[108:111], v[60:63]
    s_cbranch_vccnz LG_sp0
LG_spr0:
    ds_read_b64_tr_b16 v[144:145], v12 offset:0
    ds_read_b64_tr_b16 v[146:147], v12 offset:4096
    v_mfma_f32_16x16x32_bf16 v[32:35], v[192:195], v[104:107], v[32:35]
    ds_read_b64_tr_b16 v[148:149], v13 offset:0
    ds_read_b64_tr_b16 v[150:151], v13 offset:4096
    v_mfma_f32_16x16x32_bf16 v[64:67], v[192:195], v[108:111], v[64:67]
    ds_read_b64_tr_b16 v[152:153], v12 offset:256
    ds_read_b64_tr_b16 v[154:155], v12 offset:4352
    v_mfma_f32_16x16x32_bf16 v[36:39], v[196:199], v[104:107], v[36:39]
    ds_read_b64_tr_b16 v[156:157], v13 offset:256
    ds_read_b64_tr_b16 v[158:159], v13 offset:4352
    v_mfma_f32_16x16x32_bf16 v[68:71], v[196:199], v[108:111], v[68:71]
    ds_read_b64_tr_b16 v[160:161], v12 offset:512
    ds_read_b64_tr_b16 v[162:163], v12 offset:4608
    v_mfma_f32_16x16x32_bf16 v[40:43], v[200:203], v[104:107], v[40:43]
    ds_read_b64_tr_b16 v[164:165], v13 offset:512
    ds_read_b64_tr_b16 v[166:167], v13 offset:4608
    v_mfma_f32_16x16x32_bf16 v[72:75], v[200:203], v[108:111], v[72:75]
    ds_read_b64_tr_b16 v[168:169], v12 offset:768
    ds_read_b64_tr_b16 v[170:171], v12 offset:4864
    v_mfma_f32_16x16x32_bf16 v[44:47], v[204:207], v[104:107], v[44:47]
    ds_read_b64_tr_b16 v[172:173], v13 offset:768
    ds_read_b64_tr_b16 v[174:175], v13 offset:4864
    v_mfma_f32_16x16x32_bf16 v[76:79], v[204:207], v[108:111], v[76:79]
    s_add_u32 s63, s63, 32768
    s_cmp_eq_u32 s63, 98304
    s_cselect_b32 s63, 0, s63
    buffer_load_dwordx4 v[104:107], v6, s[20:23], s53 offen offset:3072 sc1
    buffer_load_dwordx4 v[108:111], v7, s[20:23], s53 offen offset:3072 sc1
    s_add_u32 s53, s53, 0x1000
    s_add_u32 s59, s59, 1
    s_cmp_ge_u32 s59, 15
    s_cbranch_scc1 LG_so1
LG_sg1:
LG_l2b:
    s_waitcnt vmcnt(28) lgkmcnt(0)
    v_mfma_f32_16x16x32_bf16 v[16:19], v[144:147], v[112:115], v[16:19]
    ds_read_b64_tr_b16 v[176:177], v12 offset:8192
    ds_read_b64_tr_b16 v[178:179], v12 offset:12288
    v_mfma_f32_16x16x32_bf16 v[48:51], v[144:147], v[116:119], v[48:51]
    ds_read_b64_tr_b16 v[180:181], v13 offset:8192
    ds_read_b64_tr_b16 v[182:183], v13 offset:12288
    v_mfma_f32_16x16x32_bf16 v[20:23], v[148:151], v[112:115], v[20:23]
    ds_read_b64_tr_b16 v[184:185], v12 offset:8448
    ds_read_b64_tr_b16 v[186:187], v12 offset:12544
    v_mfma_f32_16x16x32_bf16 v[52:55], v[148:151], v[116:119], v[52:55]
    ds_read_b64_tr_b16 v[188:189], v13 offset:8448
    ds_read_b64_tr_b16 v[190:191], v13 offset:12544
    v_mfma_f32_16x16x32_bf16 v[24:27], v[152:155], v[112:115], v[24:27]
    ds_read_b64_tr_b16 v[192:193], v12 offset:8704
    ds_read_b64_tr_b16 v[194:195], v12 offset:12800
    v_mfma_f32_16x16x32_bf16 v[56:59], v[152:155], v[116:119], v[56:59]
    ds_read_b64_tr_b16 v[196:197], v13 offset:8704
    ds_read_b64_tr_b16 v[198:199], v13 offset:12800
    v_mfma_f32_16x16x32_bf16 v[28:31], v[156:159], v[112:115], v[28:31]
    ds_read_b64_tr_b16 v[200:201], v12 offset:8960
    ds_read_b64_tr_b16 v[202:203], v12 offset:13056
    v_mfma_f32_16x16x32_bf16 v[60:63], v[156:159], v[116:119], v[60:63]
    ds_read_b64_tr_b16 v[204:205], v13 offset:8960
    ds_read_b64_tr_b16 v[206:207], v13 offset:13056
    v_mfma_f32_16x16x32_bf16 v[32:35], v[160:163], v[112:115], v[32:35]
    s_add_u32 m0, s56, 0
    s_mov_b32 s55, s54
    v_mfma_f32_16x16x32_bf16 v[64:67], v[160:163], v[116:119], v[64:67]
    buffer_load_dwordx4 v8, s[16:19], s55 offen lds
    v_mfma_f32_16x16x32_bf16 v[36:39], v[164:167], v[112:115], v[36:39]
    s_add_u32 m0, s56, 1024
    s_add_u32 s55, s55, s57
    v_mfma_f32_16x16x32_bf16 v[68:71], v[164:167], v[116:119], v[68:71]
    buffer_load_dwordx4 v9, s[16:19], s55 offen lds
    v_mfma_f32_16x16x32_bf16 v[40:43], v[168:171], v[112:115], v[40:43]
    v_mfma_f32_16x16x32_bf16 v[72:75], v[168:171], v[116:119], v[72:75]
    v_mfma_f32_16x16x32_bf16 v[44:47], v[172:175], v[112:115], v[44:47]
    v_mfma_f32_16x16x32_bf16 v[76:79], v[172:175], v[116:119], v[76:79]
    buffer_load_dwordx4 v[112:115], v6, s[20:23], s53 offen offset:0 sc1
    buffer_load_dwordx4 v[116:119], v7, s[20:23], s53 offen offset:0 sc1
    s_waitcnt vmcnt(28) lgkmcnt(0)
    v_mfma_f32_16x16x32_bf16 v[16:19], v[176:179], v[120:123], v[16:19]
    ds_read_b64_tr_b16 v[144:145], v12 offset:16384
    ds_read_b64_tr_b16 v[146:147], v12 offset:20480
    v_mfma_f32_16x16x32_bf16 v[48:51], v[176:179], v[124:127], v[48:51]
    ds_read_b64_tr_b16 v[148:149], v13 offset:16384
    ds_read_b64_tr_b16 v[150:151], v13 offset:20480
    v_mfma_f32_16x16x32_bf16 v[20:23], v[180:183], v[120:123], v[20:23]
    ds_read_b64_tr_b16 v[152:153], v12 offset:16640
    ds_read_b64_tr_b16 v[154:155], v12 offset:20736
    v_mfma_f32_16x16x32_bf16 v[52:55], v[180:183], v[124:127], v[52:55]
    ds_read_b64_tr_b16 v[156:157], v13 offset:16640
    ds_read_b64_tr_b16 v[158:159], v13 offset:20736
    v_mfma_f32_16x16x32_bf16 v[24:27], v[184:187], v[120:123], v[24:27]
    ds_read_b64_tr_b16 v[160:161], v12 offset:16896
    ds_read_b64_tr_b16 v[162:163], v12 offset:20992
    v_mfma_f32_16x16x32_bf16 v[56:59], v[184:187], v[124:127], v[56:59]
    ds_read_b64_tr_b16 v[164:165], v13 offset:16896
    ds_read_b64_tr_b16 v[166:167], v13 offset:20992
    v_mfma_f32_16x16x32_bf16 v[28:31], v[188:191], v[120:123], v[28:31]
    ds_read_b64_tr_b16 v[168:169], v12 offset:17152
    ds_read_b64_tr_b16 v[170:171], v12 offset:21248
    v_mfma_f32_16x16x32_bf16 v[60:63], v[188:191], v[124:127], v[60:63]
    ds_read_b64_tr_b16 v[172:173], v13 offset:17152
    ds_read_b64_tr_b16 v[174:175], v13 offset:21248
    v_mfma_f32_16x16x32_bf16 v[32:35], v[192:195], v[120:123], v[32:35]
    s_add_u32 m0, s56, 2048
    s_add_u32 s55, s55, s57
    v_mfma_f32_16x16x32_bf16 v[64:67], v[192:195], v[124:127], v[64:67]
    buffer_load_dwordx4 v8, s[16:19], s55 offen lds
    v_mfma_f32_16x16x32_bf16 v[36:39], v[196:199], v[120:123], v[36:39]
    s_add_u32 m0, s56, 3072
    s_add_u32 s55, s55, s57
    v_mfma_f32_16x16x32_bf16 v[68:71], v[196:199], v[124:127], v[68:71]
    buffer_load_dwordx4 v9, s[16:19], s55 offen lds
    v_mfma_f32_16x16x32_bf16 v[40:43], v[200:203], v[120:123], v[40:43]
    v_mfma_f32_16x16x32_bf16 v[72:75], v[200:203], v[124:127], v[72:75]
    v_mfma_f32_16x16x32_bf16 v[44:47], v[204:207], v[120:123], v[44:47]
    v_mfma_f32_16x16x32_bf16 v[76:79], v[204:207], v[124:127], v[76:79]
    buffer_load_dwordx4 v[120:123], v6, s[20:23], s53 offen offset:1024 sc1
    buffer_load_dwordx4 v[124:127], v7, s[20:23], s53 offen offset:1024 sc1
    s_waitcnt vmcnt(28) lgkmcnt(0)
    v_mfma_f32_16x16x32_bf16 v[16:19], v[144:147], v[128:131], v[16:19]
    ds_read_b64_tr_b16 v[176:177], v12 offset:24576
    ds_read_b64_tr_b16 v[178:179], v12 offset:28672
    v_mfma_f32_16x16x32_bf16 v[48:51], v[144:147], v[132:135], v[48:51]
    ds_read_b64_tr_b16 v[180:181], v13 offset:24576
    ds_read_b64_tr_b16 v[182:183], v13 offset:28672
    v_mfma_f32_16x16x32_bf16 v[20:23], v[148:151], v[128:131], v[20:23]
    ds_read_b64_tr_b16 v[184:185], v12 offset:24832
    ds_read_b64_tr_b16 v[186:187], v12 offset:28928
    v_mfma_f32_16x16x32_bf16 v[52:55], v[148:151], v[132:135], v[52:55]
    ds_read_b64_tr_b16 v[188:189], v13 offset:24832
    ds_read_b64_tr_b16 v[190:191], v13 offset:28928
    v_mfma_f32_16x16x32_bf16 v[24:27], v[152:155], v[128:131], v[24:27]
    ds_read_b64_tr_b16 v[192:193], v12 offset:25088
    ds_read_b64_tr_b16 v[194:195], v12 offset:29184
    v_mfma_f32_16x16x32_bf16 v[56:59], v[152:155], v[132:135], v[56:59]
    ds_read_b64_tr_b16 v[196:197], v13 offset:25088
    ds_read_b64_tr_b16 v[198:199], v13 offset:29184
    v_mfma_f32_16x16x32_bf16 v[28:31], v[156:159], v[128:131], v[28:31]
    ds_read_b64_tr_b16 v[200:201], v12 offset:25344
    ds_read_b64_tr_b16 v[202:203], v12 offset:29440
    v_mfma_f32_16x16x32_bf16 v[60:63], v[156:159], v[132:135], v[60:63]
    ds_read_b64_tr_b16 v[204:205], v13 offset:25344
    ds_read_b64_tr_b16 v[206:207], v13 offset:29440
    v_mfma_f32_16x16x32_bf16 v[32:35], v[160:163], v[128:131], v[32:35]
    s_add_u32 m0, s56, 4096
    s_add_u32 s55, s55, s57
    v_mfma_f32_16x16x32_bf16 v[64:67], v[160:163], v[132:135], v[64:67]
    buffer_load_dwordx4 v8, s[16:19], s55 offen lds
    v_mfma_f32_16x16x32_bf16 v[36:39], v[164:167], v[128:131], v[36:39]
    s_add_u32 m0, s56, 5120
    s_add_u32 s55, s55, s57
    v_mfma_f32_16x16x32_bf16 v[68:71], v[164:167], v[132:135], v[68:71]
    buffer_load_dwordx4 v9, s[16:19], s55 offen lds
    v_mfma_f32_16x16x32_bf16 v[40:43], v[168:171], v[128:131], v[40:43]
    s_add_u32 s60, s58, 32768
    s_cmp_eq_u32 s60, 98304
    s_cselect_b32 s60, 0, s60
    v_mfma_f32_16x16x32_bf16 v[72:75], v[168:171], v[132:135], v[72:75]
    s_sub_u32 s61, s60, s58
    s_mov_b32 s58, s60
    v_mfma_f32_16x16x32_bf16 v[44:47], v[172:175], v[128:131], v[44:47]
    s_setprio 2
    v_add_u32 v12, s61, v12
    v_add_u32 v13, s61, v13
    v_add_u32 v240, 1, v240
    s_setprio 0
    v_mfma_f32_16x16x32_bf16 v[76:79], v[172:175], v[132:135], v[76:79]
    buffer_load_dwordx4 v[128:131], v6, s[20:23], s53 offen offset:2048 sc1
    buffer_load_dwordx4 v[132:135], v7, s[20:23], s53 offen offset:2048 sc1
    s_waitcnt vmcnt(14) lgkmcnt(0)
    ds_write_b32 v254, v240 offset:64
    v_mfma_f32_16x16x32_bf16 v[16:19], v[176:179], v[136:139], v[16:19]
    s_add_u32 m0, s56, 6144
    s_add_u32 s55, s55, s57
    v_mfma_f32_16x16x32_bf16 v[48:51], v[176:179], v[140:143], v[48:51]
    buffer_load_dwordx4 v8, s[16:19], s55 offen lds
    v_mfma_f32_16x16x32_bf16 v[20:23], v[180:183], v[136:139], v[20:23]
    ds_read_b32 v241, v255 offset:64
    v_mfma_f32_16x16x32_bf16 v[52:55], v[180:183], v[140:143], v[52:55]
    s_add_u32 m0, s56, 7168
    s_add_u32 s55, s55, s57
    v_mfma_f32_16x16x32_bf16 v[24:27], v[184:187], v[136:139], v[24:27]
    buffer_load_dwordx4 v9, s[16:19], s55 offen lds
    v_mfma_f32_16x16x32_bf16 v[56:59], v[184:187], v[140:143], v[56:59]
    s_add_u32 s54, s54, 0x40000
    s_add_u32 s56, s52, s63
    v_mfma_f32_16x16x32_bf16 v[28:31], v[188:191], v[136:139], v[28:31]
    s_waitcnt lgkmcnt(0)
    s_setprio 2
    v_cmp_gt_u32 vcc, v240, v241
    s_setprio 0
    v_mfma_f32_16x16x32_bf16 v[60:63], v[188:191], v[140:143], v[60:63]
    s_cbranch_vccnz LG_sp1
LG_spr1:
    ds_read_b64_tr_b16 v[144:145], v12 offset:0
    ds_read_b64_tr_b16 v[146:147], v12 offset:4096
    v_mfma_f32_16x16x32_bf16 v[32:35], v[192:195], v[136:139], v[32:35]
    ds_read_b64_tr_b16 v[148:149], v13 offset:0
    ds_read_b64_tr_b16 v[150:151], v13 offset:4096
    v_mfma_f32_16x16x32_bf16 v[64:67], v[192:195], v[140:143], v[64:67]
    ds_read_b64_tr_b16 v[152:153], v12 offset:256
    ds_read_b64_tr_b16 v[154:155], v12 offset:4352
    v_mfma_f32_16x16x32_bf16 v[36:39], v[196:199], v[136:139], v[36:39]
    ds_read_b64_tr_b16 v[156:157], v13 offset:256
    ds_read_b64_tr_b16 v[158:159], v13 offset:4352
    v_mfma_f32_16x16x32_bf16 v[68:71], v[196:199], v[140:143], v[68:71]
    ds_read_b64_tr_b16 v[160:161], v12 offset:512
    ds_read_b64_tr_b16 v[162:163], v12 offset:4608
    v_mfma_f32_16x16x32_bf16 v[40:43], v[200:203], v[136:139], v[40:43]
    ds_read_b64_tr_b16 v[164:165], v13 offset:512
    ds_read_b64_tr_b16 v[166:167], v13 offset:4608
    v_mfma_f32_16x16x32_bf16 v[72:75], v[200:203], v[140:143], v[72:75]
    ds_read_b64_tr_b16 v[168:169], v12 offset:768
    ds_read_b64_tr_b16 v[170:171], v12 offset:4864
    v_mfma_f32_16x16x32_bf16 v[44:47], v[204:207], v[136:139], v[44:47]
    ds_read_b64_tr_b16 v[172:173], v13 offset:768
    ds_read_b64_tr_b16 v[174:175], v13 offset:4864
    v_mfma_f32_16x16x32_bf16 v[76:79], v[204:207], v[140:143], v[76:79]
    s_add_u32 s63, s63, 32768
    s_cmp_eq_u32 s63, 98304
    s_cselect_b32 s63, 0, s63
    buffer_load_dwordx4 v[136:139], v6, s[20:23], s53 offen offset:3072 sc1
    buffer_load_dwordx4 v[140:143], v7, s[20:23], s53 offen offset:3072 sc1
    s_add_u32 s53, s53, 0x1000
    s_add_u32 s59, s59, 1
    s_cmp_ge_u32 s59, 15
    s_cbranch_scc1 LG_so2
LG_sg2:
    s_cmp_lt_u32 s59, 17
    s_cbranch_scc1 LG_l2
LG_tail:
    s_lshl_b32 s55, s40, 14
    s_add_u32 s55, s55, 0x1f0000
    s_lshl_b32 s56, s40, 10
    s_add_u32 m0, s56, 94208
    s_nop 0
    buffer_load_dwordx4 v10, s[16:19], s55 offen lds
    s_lshl_b32 s47, s41, 3
    s_add_u32 s47, s47, s42
    s_lshl_b32 s47, s47, 1
    s_add_u32 s47, s47, s44
    s_xor_b32 s49, s47, 1
    s_lshl_b32 s50, s47, 2
    s_add_u32 s50, s50, s40
    s_lshl_b32 s50, s50, 12
    s_add_u32 s50, s50, 0x2400000
    s_waitcnt lgkmcnt(0)
    v_cvt_pk_bf16_f32 v144, v32, v33
    v_cvt_pk_bf16_f32 v145, v34, v35
    v_cvt_pk_bf16_f32 v146, v36, v37
    v_cvt_pk_bf16_f32 v147, v38, v39
    v_cvt_pk_bf16_f32 v148, v40, v41
    v_cvt_pk_bf16_f32 v149, v42, v43
    v_cvt_pk_bf16_f32 v150, v44, v45
    v_cvt_pk_bf16_f32 v151, v46, v47
    v_cvt_pk_bf16_f32 v152, v64, v65
    v_cvt_pk_bf16_f32 v153, v66, v67
    v_cvt_pk_bf16_f32 v154, v68, v69
    v_cvt_pk_bf16_f32 v155, v70, v71
    v_cvt_pk_bf16_f32 v156, v72, v73
    v_cvt_pk_bf16_f32 v157, v74, v75
    v_cvt_pk_bf16_f32 v158, v76, v77
    v_cvt_pk_bf16_f32 v159, v78, v79
    buffer_store_dwordx4 v[144:147], v5, s[24:27], s50 offen offset:0 sc1
    buffer_store_dwordx4 v[148:151], v5, s[24:27], s50 offen offset:1024 sc1
    buffer_store_dwordx4 v[152:155], v5, s[24:27], s50 offen offset:2048 sc1
    buffer_store_dwordx4 v[156:159], v5, s[24:27], s50 offen offset:3072 sc1
    s_lshl_b32 s47, s47, 7
    s_lshl_b32 s55, s41, 9
    s_add_u32 s55, s55, s40
    s_lshl_b32 s55, s55, 2
    s_add_u32 s47, s47, s55
    s_add_u32 s47, s47, 0x2e00000
    s_lshl_b32 s53, s49, 7
    s_add_u32 s53, s53, s55
    s_add_u32 s53, s53, 0x2e00000
    s_lshl_b32 s50, s49, 2
    s_add_u32 s50, s50, s40
    s_lshl_b32 s50, s50, 12
    s_add_u32 s50, s50, 0x2400000
    v_add_u32 v12, 126976, v242
    v_xor_b32 v13, 32, v12
    v_lshlrev_b32 v228, 16, v224
    v_and_b32 v229, 0xffff0000, v224
    v_lshlrev_b32 v230, 16, v225
    v_and_b32 v231, 0xffff0000, v225
    v_lshlrev_b32 v232, 16, v226
    v_and_b32 v233, 0xffff0000, v226
    v_lshlrev_b32 v234, 16, v227
    v_and_b32 v235, 0xffff0000, v227
    v_lshlrev_b32 v32, 16, v208
    v_and_b32 v33, 0xffff0000, v208
    v_pk_add_f32 v[32:33], v[32:33], v[228:229]
    v_lshlrev_b32 v34, 16, v209
    v_and_b32 v35, 0xffff0000, v209
    v_pk_add_f32 v[34:35], v[34:35], v[230:231]
    v_lshlrev_b32 v36, 16, v210
    v_and_b32 v37, 0xffff0000, v210
    v_pk_add_f32 v[36:37], v[36:37], v[232:233]
    v_lshlrev_b32 v38, 16, v211
    v_and_b32 v39, 0xffff0000, v211
    v_pk_add_f32 v[38:39], v[38:39], v[234:235]
    v_lshlrev_b32 v40, 16, v212
    v_and_b32 v41, 0xffff0000, v212
    v_pk_add_f32 v[40:41], v[40:41], v[228:229]
    v_lshlrev_b32 v42, 16, v213
    v_and_b32 v43, 0xffff0000, v213
    v_pk_add_f32 v[42:43], v[42:43], v[230:231]
    v_lshlrev_b32 v44, 16, v214
    v_and_b32 v45, 0xffff0000, v214
    v_pk_add_f32 v[44:45], v[44:45], v[232:233]
    v_lshlrev_b32 v46, 16, v215
    v_and_b32 v47, 0xffff0000, v215
    v_pk_add_f32 v[46:47], v[46:47], v[234:235]
    v_lshlrev_b32 v192, 16, v216
    v_and_b32 v193, 0xffff0000, v216
    v_pk_add_f32 v[192:193], v[192:193], v[228:229]
    v_lshlrev_b32 v194, 16, v217
    v_and_b32 v195, 0xffff0000, v217
    v_pk_add_f32 v[194:195], v[194:195], v[230:231]
    v_lshlrev_b32 v196, 16, v218
    v_and_b32 v197, 0xffff0000, v218
    v_pk_add_f32 v[196:197], v[196:197], v[232:233]
    v_lshlrev_b32 v198, 16, v219
    v_and_b32 v199, 0xffff0000, v219
    v_pk_add_f32 v[198:199], v[198:199], v[234:235]
    v_lshlrev_b32 v200, 16, v220
    v_and_b32 v201, 0xffff0000, v220
    v_pk_add_f32 v[200:201], v[200:201], v[228:229]
    v_lshlrev_b32 v202, 16, v221
    v_and_b32 v203, 0xffff0000, v221
    v_pk_add_f32 v[202:203], v[202:203], v[230:231]
    v_lshlrev_b32 v204, 16, v222
    v_and_b32 v205, 0xffff0000, v222
    v_pk_add_f32 v[204:205], v[204:205], v[232:233]
    v_lshlrev_b32 v206, 16, v223
    v_and_b32 v207, 0xffff0000, v223
    v_pk_add_f32 v[206:207], v[206:207], v[234:235]
    s_mov_b32 s22, 18874368
    s_mov_b32 s37, s36
    s_mov_b32 s36, s53
    s_mov_b32 s64, s28
    s_and_b32 s65, s29, 0xffff
    s_mov_b32 s66, 0x400000
    s_mov_b32 s67, 0x20000
    v_add_u32 v247, 94208, v242
    v_xor_b32 v248, 32, v247
    v_add_u32 v240, 1, v240
    v_mov_b32 v249, 34
    s_waitcnt vmcnt(0)
    s_mov_b64 exec, 1
    buffer_store_dword v11, v244, s[24:27], s47 offen sc1
    s_mov_b64 exec, -1
    ds_write_b32 v254, v240 offset:64
    ds_read_b64_tr_b16 v[144:145], v12 offset:0
    ds_read_b64_tr_b16 v[146:147], v12 offset:2048
    ds_read_b64_tr_b16 v[148:149], v13 offset:0
    ds_read_b64_tr_b16 v[150:151], v13 offset:2048
    ds_read_b64_tr_b16 v[152:153], v12 offset:256
    ds_read_b64_tr_b16 v[154:155], v12 offset:2304
    ds_read_b64_tr_b16 v[156:157], v13 offset:256
    ds_read_b64_tr_b16 v[158:159], v13 offset:2304
    ds_read_b64_tr_b16 v[160:161], v12 offset:4096
    ds_read_b64_tr_b16 v[162:163], v12 offset:6144
    ds_read_b64_tr_b16 v[164:165], v13 offset:4096
    ds_read_b64_tr_b16 v[166:167], v13 offset:6144
    ds_read_b64_tr_b16 v[168:169], v12 offset:4352
    ds_read_b64_tr_b16 v[170:171], v12 offset:6400
    ds_read_b64_tr_b16 v[172:173], v13 offset:4352
    ds_read_b64_tr_b16 v[174:175], v13 offset:6400
    s_mov_b32 s3, 0
LG_w3:
    ds_read_b32 v241, v255 offset:48
    s_add_u32 s3, s3, 1
    s_waitcnt lgkmcnt(0)
    v_cmp_gt_u32 vcc, v249, v241
    s_nop 4
    s_cbranch_vccz LG_w3_ok
    s_sleep 1
    s_cmp_lt_u32 s3, 8000000
    s_cbranch_scc1 LG_w3
LG_w3_ok:
    s_mov_b32 s58, 0
LG_p2:
    buffer_load_dword v246, v245, s[24:27], s37 offen sc1
    s_add_u32 s58, s58, 1
    s_waitcnt vmcnt(0)
    v_cmp_ne_u32 vcc, 1, v246
    s_nop 4
    s_cbranch_vccz LG_p2_ok
    s_sleep 8
    s_cmp_lt_u32 s58, 1000000
    s_cbranch_scc1 LG_p2
LG_p2_ok:
    s_mov_b32 s53, 0
    buffer_load_dwordx4 v[80:83], v6, s[20:23], s53 offen offset:0 sc1
    buffer_load_dwordx4 v[84:87], v7, s[20:23], s53 offen offset:0 sc1
    buffer_load_dwordx4 v[88:91], v6, s[20:23], s53 offen offset:1024 sc1
    buffer_load_dwordx4 v[92:95], v7, s[20:23], s53 offen offset:1024 sc1
    buffer_load_dwordx4 v[96:99], v6, s[20:23], s53 offen offset:2048 sc1
    buffer_load_dwordx4 v[100:103], v7, s[20:23], s53 offen offset:2048 sc1
    buffer_load_dwordx4 v[104:107], v6, s[20:23], s53 offen offset:3072 sc1
    buffer_load_dwordx4 v[108:111], v7, s[20:23], s53 offen offset:3072 sc1
    s_mov_b32 s53, 4096
    buffer_load_dwordx4 v[112:115], v6, s[20:23], s53 offen offset:0 sc1
    buffer_load_dwordx4 v[116:119], v7, s[20:23], s53 offen offset:0 sc1
    buffer_load_dwordx4 v[120:123], v6, s[20:23], s53 offen offset:1024 sc1
    buffer_load_dwordx4 v[124:127], v7, s[20:23], s53 offen offset:1024 sc1
    buffer_load_dwordx4 v[128:131], v6, s[20:23], s53 offen offset:2048 sc1
    buffer_load_dwordx4 v[132:135], v7, s[20:23], s53 offen offset:2048 sc1
LG_go7:
    v_xor_b32 v8, v3, v4
    v_lshlrev_b32 v8, 4, v8
    v_lshl_add_u32 v8, v3, 8, v8
    s_lshl_b32 s56, s40, 12
    s_add_u32 s56, s56, 126976
    v_add_u32 v8, s56, v8
    v_xor_b32 v9, 64, v8
    v_mov_b32 v250, v10
    v_xor_b32 v10, 0x80, v8
    v_xor_b32 v11, 0xc0, v8
    s_waitcnt vmcnt(12) lgkmcnt(8)
    v_mfma_f32_16x16x32_bf16 v[16:19], v[144:147], v[80:83], v[16:19]
    ds_read_b64_tr_b16 v[176:177], v12 offset:8192
    v_mfma_f32_16x16x32_bf16 v[48:51], v[144:147], v[84:87], v[48:51]
    ds_read_b64_tr_b16 v[178:179], v12 offset:10240
    buffer_load_dwordx4 v[136:139], v6, s[20:23], s53 offen offset:3072 sc1
    v_mfma_f32_16x16x32_bf16 v[20:23], v[148:151], v[80:83], v[20:23]
    ds_read_b64_tr_b16 v[180:181], v13 offset:8192
    v_mfma_f32_16x16x32_bf16 v[52:55], v[148:151], v[84:87], v[52:55]
    ds_read_b64_tr_b16 v[182:183], v13 offset:10240
    v_mfma_f32_16x16x32_bf16 v[24:27], v[152:155], v[80:83], v[24:27]
    ds_read_b64_tr_b16 v[184:185], v12 offset:8448
    buffer_load_dwordx4 v[140:143], v7, s[20:23], s53 offen offset:3072 sc1
    v_mfma_f32_16x16x32_bf16 v[56:59], v[152:155], v[84:87], v[56:59]
    ds_read_b64_tr_b16 v[186:187], v12 offset:10496
    v_mfma_f32_16x16x32_bf16 v[28:31], v[156:159], v[80:83], v[28:31]
    ds_read_b64_tr_b16 v[188:189], v13 offset:8448
    v_mfma_f32_16x16x32_bf16 v[60:63], v[156:159], v[84:87], v[60:63]
    ds_read_b64_tr_b16 v[190:191], v13 offset:10496
    s_waitcnt vmcnt(12) lgkmcnt(8)
    v_mfma_f32_16x16x32_bf16 v[16:19], v[160:163], v[88:91], v[16:19]
    ds_read_b64_tr_b16 v[144:145], v12 offset:12288
    s_mov_b32 s53, 8192
    v_mfma_f32_16x16x32_bf16 v[48:51], v[160:163], v[92:95], v[48:51]
    ds_read_b64_tr_b16 v[146:147], v12 offset:14336
    buffer_load_dwordx4 v[80:83], v6, s[20:23], s53 offen offset:0 sc1
    v_mfma_f32_16x16x32_bf16 v[20:23], v[164:167], v[88:91], v[20:23]
    ds_read_b64_tr_b16 v[148:149], v13 offset:12288
    v_mfma_f32_16x16x32_bf16 v[52:55], v[164:167], v[92:95], v[52:55]
    ds_read_b64_tr_b16 v[150:151], v13 offset:14336
    v_mfma_f32_16x16x32_bf16 v[24:27], v[168:171], v[88:91], v[24:27]
    ds_read_b64_tr_b16 v[152:153], v12 offset:12544
    buffer_load_dwordx4 v[84:87], v7, s[20:23], s53 offen offset:0 sc1
    v_mfma_f32_16x16x32_bf16 v[56:59], v[168:171], v[92:95], v[56:59]
    ds_read_b64_tr_b16 v[154:155], v12 offset:14592
    v_mfma_f32_16x16x32_bf16 v[28:31], v[172:175], v[88:91], v[28:31]
    ds_read_b64_tr_b16 v[156:157], v13 offset:12544
    v_mfma_f32_16x16x32_bf16 v[60:63], v[172:175], v[92:95], v[60:63]
    ds_read_b64_tr_b16 v[158:159], v13 offset:14592
    s_waitcnt vmcnt(12) lgkmcnt(8)
    v_mfma_f32_16x16x32_bf16 v[16:19], v[176:179], v[96:99], v[16:19]
    ds_read_b64_tr_b16 v[160:161], v12 offset:16384
    v_mfma_f32_16x16x32_bf16 v[48:51], v[176:179], v[100:103], v[48:51]
    ds_read_b64_tr_b16 v[162:163], v12 offset:18432
    buffer_load_dwordx4 v[88:91], v6, s[20:23], s53 offen offset:1024 sc1
    v_mfma_f32_16x16x32_bf16 v[20:23], v[180:183], v[96:99], v[20:23]
    ds_read_b64_tr_b16 v[164:165], v13 offset:16384
    v_mfma_f32_16x16x32_bf16 v[52:55], v[180:183], v[100:103], v[52:55]
    ds_read_b64_tr_b16 v[166:167], v13 offset:18432
    v_mfma_f32_16x16x32_bf16 v[24:27], v[184:187], v[96:99], v[24:27]
    ds_read_b64_tr_b16 v[168:169], v12 offset:16640
    buffer_load_dwordx4 v[92:95], v7, s[20:23], s53 offen offset:1024 sc1
    v_mfma_f32_16x16x32_bf16 v[56:59], v[184:187], v[100:103], v[56:59]
    ds_read_b64_tr_b16 v[170:171], v12 offset:18688
    v_mfma_f32_16x16x32_bf16 v[28:31], v[188:191], v[96:99], v[28:31]
    ds_read_b64_tr_b16 v[172:173], v13 offset:16640
    v_mfma_f32_16x16x32_bf16 v[60:63], v[188:191], v[100:103], v[60:63]
    ds_read_b64_tr_b16 v[174:175], v13 offset:18688
    s_waitcnt vmcnt(12) lgkmcnt(8)
    v_mfma_f32_16x16x32_bf16 v[16:19], v[144:147], v[104:107], v[16:19]
    ds_read_b64_tr_b16 v[176:177], v12 offset:20480
    v_mfma_f32_16x16x32_bf16 v[48:51], v[144:147], v[108:111], v[48:51]
    ds_read_b64_tr_b16 v[178:179], v12 offset:22528
    buffer_load_dwordx4 v[96:99], v6, s[20:23], s53 offen offset:2048 sc1
    v_mfma_f32_16x16x32_bf16 v[20:23], v[148:151], v[104:107], v[20:23]
    ds_read_b64_tr_b16 v[180:181], v13 offset:20480
    v_mfma_f32_16x16x32_bf16 v[52:55], v[148:151], v[108:111], v[52:55]
    ds_read_b64_tr_b16 v[182:183], v13 offset:22528
    v_mfma_f32_16x16x32_bf16 v[24:27], v[152:155], v[104:107], v[24:27]
    ds_read_b64_tr_b16 v[184:185], v12 offset:20736
    buffer_load_dwordx4 v[100:103], v7, s[20:23], s53 offen offset:2048 sc1
    v_mfma_f32_16x16x32_bf16 v[56:59], v[152:155], v[108:111], v[56:59]
    ds_read_b64_tr_b16 v[186:187], v12 offset:22784
    v_mfma_f32_16x16x32_bf16 v[28:31], v[156:159], v[104:107], v[28:31]
    ds_read_b64_tr_b16 v[188:189], v13 offset:20736
    v_mfma_f32_16x16x32_bf16 v[60:63], v[156:159], v[108:111], v[60:63]
    ds_read_b64_tr_b16 v[190:191], v13 offset:22784
    s_waitcnt vmcnt(12) lgkmcnt(8)
    v_mfma_f32_16x16x32_bf16 v[16:19], v[160:163], v[112:115], v[16:19]
    ds_read_b64_tr_b16 v[144:145], v12 offset:24576
    v_mfma_f32_16x16x32_bf16 v[48:51], v[160:163], v[116:119], v[48:51]
    ds_read_b64_tr_b16 v[146:147], v12 offset:26624
    buffer_load_dwordx4 v[104:107], v6, s[20:23], s53 offen offset:3072 sc1
    v_mfma_f32_16x16x32_bf16 v[20:23], v[164:167], v[112:115], v[20:23]
    ds_read_b64_tr_b16 v[148:149], v13 offset:24576
    v_mfma_f32_16x16x32_bf16 v[52:55], v[164:167], v[116:119], v[52:55]
    ds_read_b64_tr_b16 v[150:151], v13 offset:26624
    v_mfma_f32_16x16x32_bf16 v[24:27], v[168:171], v[112:115], v[24:27]
    ds_read_b64_tr_b16 v[152:153], v12 offset:24832
    buffer_load_dwordx4 v[108:111], v7, s[20:23], s53 offen offset:3072 sc1
    v_mfma_f32_16x16x32_bf16 v[56:59], v[168:171], v[116:119], v[56:59]
    ds_read_b64_tr_b16 v[154:155], v12 offset:26880
    v_mfma_f32_16x16x32_bf16 v[28:31], v[172:175], v[112:115], v[28:31]
    ds_read_b64_tr_b16 v[156:157], v13 offset:24832
    v_mfma_f32_16x16x32_bf16 v[60:63], v[172:175], v[116:119], v[60:63]
    ds_read_b64_tr_b16 v[158:159], v13 offset:26880
    s_waitcnt vmcnt(12) lgkmcnt(8)
    v_mfma_f32_16x16x32_bf16 v[16:19], v[176:179], v[120:123], v[16:19]
    ds_read_b64_tr_b16 v[160:161], v12 offset:28672
    s_mov_b32 s53, 12288
    v_mfma_f32_16x16x32_bf16 v[48:51], v[176:179], v[124:127], v[48:51]
    ds_read_b64_tr_b16 v[162:163], v12 offset:30720
    buffer_load_dwordx4 v[112:115], v6, s[20:23], s53 offen offset:0 sc1
    v_mfma_f32_16x16x32_bf16 v[20:23], v[180:183], v[120:123], v[20:23]
    ds_read_b64_tr_b16 v[164:165], v13 offset:28672
    v_mfma_f32_16x16x32_bf16 v[52:55], v[180:183], v[124:127], v[52:55]
    ds_read_b64_tr_b16 v[166:167], v13 offset:30720
    v_mfma_f32_16x16x32_bf16 v[24:27], v[184:187], v[120:123], v[24:27]
    ds_read_b64_tr_b16 v[168:169], v12 offset:28928
    buffer_load_dwordx4 v[116:119], v7, s[20:23], s53 offen offset:0 sc1
    v_mfma_f32_16x16x32_bf16 v[56:59], v[184:187], v[124:127], v[56:59]
    ds_read_b64_tr_b16 v[170:171], v12 offset:30976
    v_mfma_f32_16x16x32_bf16 v[28:31], v[188:191], v[120:123], v[28:31]
    ds_read_b64_tr_b16 v[172:173], v13 offset:28928
    v_mfma_f32_16x16x32_bf16 v[60:63], v[188:191], v[124:127], v[60:63]
    ds_read_b64_tr_b16 v[174:175], v13 offset:30976
    s_waitcnt vmcnt(12) lgkmcnt(8)
    s_mov_b32 s3, 0
LG_w4:
    ds_read_b32 v241, v255 offset:64
    s_add_u32 s3, s3, 1
    s_waitcnt lgkmcnt(0)
    v_cmp_gt_u32 vcc, v240, v241
    s_nop 4
    s_cbranch_vccz LG_w4_ok
    s_sleep 1
    s_cmp_lt_u32 s3, 8000000
    s_cbranch_scc1 LG_w4
LG_w4_ok:
    v_add_u32 v12, 0xffff0000, v12
    v_add_u32 v13, 0xffff0000, v13
    v_mfma_f32_16x16x32_bf16 v[16:19], v[144:147], v[128:131], v[16:19]
    ds_read_b64_tr_b16 v[176:177], v12 offset:0
    v_mfma_f32_16x16x32_bf16 v[48:51], v[144:147], v[132:135], v[48:51]
    ds_read_b64_tr_b16 v[178:179], v12 offset:2048
    buffer_load_dwordx4 v[120:123], v6, s[20:23], s53 offen offset:1024 sc1
    v_mfma_f32_16x16x32_bf16 v[20:23], v[148:151], v[128:131], v[20:23]
    ds_read_b64_tr_b16 v[180:181], v13 offset:0
    v_mfma_f32_16x16x32_bf16 v[52:55], v[148:151], v[132:135], v[52:55]
    ds_read_b64_tr_b16 v[182:183], v13 offset:2048
    v_mfma_f32_16x16x32_bf16 v[24:27], v[152:155], v[128:131], v[24:27]
    ds_read_b64_tr_b16 v[184:185], v12 offset:256
    buffer_load_dwordx4 v[124:127], v7, s[20:23], s53 offen offset:1024 sc1
    v_mfma_f32_16x16x32_bf16 v[56:59], v[152:155], v[132:135], v[56:59]
    ds_read_b64_tr_b16 v[186:187], v12 offset:2304
    v_mfma_f32_16x16x32_bf16 v[28:31], v[156:159], v[128:131], v[28:31]
    ds_read_b64_tr_b16 v[188:189], v13 offset:256
    v_mfma_f32_16x16x32_bf16 v[60:63], v[156:159], v[132:135], v[60:63]
    ds_read_b64_tr_b16 v[190:191], v13 offset:2304
    s_waitcnt vmcnt(12) lgkmcnt(8)
    v_mfma_f32_16x16x32_bf16 v[16:19], v[160:163], v[136:139], v[16:19]
    ds_read_b64_tr_b16 v[144:145], v12 offset:4096
    v_mfma_f32_16x16x32_bf16 v[48:51], v[160:163], v[140:143], v[48:51]
    ds_read_b64_tr_b16 v[146:147], v12 offset:6144
    buffer_load_dwordx4 v[128:131], v6, s[20:23], s53 offen offset:2048 sc1
    v_mfma_f32_16x16x32_bf16 v[20:23], v[164:167], v[136:139], v[20:23]
    ds_read_b64_tr_b16 v[148:149], v13 offset:4096
    v_mfma_f32_16x16x32_bf16 v[52:55], v[164:167], v[140:143], v[52:55]
    ds_read_b64_tr_b16 v[150:151], v13 offset:6144
    v_mfma_f32_16x16x32_bf16 v[24:27], v[168:171], v[136:139], v[24:27]
    ds_read_b64_tr_b16 v[152:153], v12 offset:4352
    buffer_load_dwordx4 v[132:135], v7, s[20:23], s53 offen offset:2048 sc1
    v_mfma_f32_16x16x32_bf16 v[56:59], v[168:171], v[140:143], v[56:59]
    ds_read_b64_tr_b16 v[154:155], v12 offset:6400
    v_mfma_f32_16x16x32_bf16 v[28:31], v[172:175], v[136:139], v[28:31]
    ds_read_b64_tr_b16 v[156:157], v13 offset:4352
    v_mfma_f32_16x16x32_bf16 v[60:63], v[172:175], v[140:143], v[60:63]
    ds_read_b64_tr_b16 v[158:159], v13 offset:6400
    s_waitcnt vmcnt(12) lgkmcnt(8)
    v_mfma_f32_16x16x32_bf16 v[16:19], v[176:179], v[80:83], v[16:19]
    ds_read_b64_tr_b16 v[160:161], v12 offset:8192
    v_mfma_f32_16x16x32_bf16 v[48:51], v[176:179], v[84:87], v[48:51]
    ds_read_b64_tr_b16 v[162:163], v12 offset:10240
    buffer_load_dwordx4 v[136:139], v6, s[20:23], s53 offen offset:3072 sc1
    v_mfma_f32_16x16x32_bf16 v[20:23], v[180:183], v[80:83], v[20:23]
    ds_read_b64_tr_b16 v[164:165], v13 offset:8192
    v_mfma_f32_16x16x32_bf16 v[52:55], v[180:183], v[84:87], v[52:55]
    ds_read_b64_tr_b16 v[166:167], v13 offset:10240
    v_mfma_f32_16x16x32_bf16 v[24:27], v[184:187], v[80:83], v[24:27]
    ds_read_b64_tr_b16 v[168:169], v12 offset:8448
    buffer_load_dwordx4 v[140:143], v7, s[20:23], s53 offen offset:3072 sc1
    v_mfma_f32_16x16x32_bf16 v[56:59], v[184:187], v[84:87], v[56:59]
    ds_read_b64_tr_b16 v[170:171], v12 offset:10496
    v_mfma_f32_16x16x32_bf16 v[28:31], v[188:191], v[80:83], v[28:31]
    ds_read_b64_tr_b16 v[172:173], v13 offset:8448
    buffer_load_dword v246, v244, s[24:27], s36 offen sc1
    v_mfma_f32_16x16x32_bf16 v[60:63], v[188:191], v[84:87], v[60:63]
    ds_read_b64_tr_b16 v[174:175], v13 offset:10496
    s_waitcnt vmcnt(13) lgkmcnt(8)
    v_mfma_f32_16x16x32_bf16 v[16:19], v[144:147], v[88:91], v[16:19]
    ds_read_b64_tr_b16 v[176:177], v12 offset:12288
    s_mov_b32 s53, 16384
    v_mfma_f32_16x16x32_bf16 v[48:51], v[144:147], v[92:95], v[48:51]
    ds_read_b64_tr_b16 v[178:179], v12 offset:14336
    buffer_load_dwordx4 v[80:83], v6, s[20:23], s53 offen offset:0 sc1
    v_mfma_f32_16x16x32_bf16 v[20:23], v[148:151], v[88:91], v[20:23]
    ds_read_b64_tr_b16 v[180:181], v13 offset:12288
    v_mfma_f32_16x16x32_bf16 v[52:55], v[148:151], v[92:95], v[52:55]
    ds_read_b64_tr_b16 v[182:183], v13 offset:14336
    v_mfma_f32_16x16x32_bf16 v[24:27], v[152:155], v[88:91], v[24:27]
    ds_read_b64_tr_b16 v[184:185], v12 offset:12544
    buffer_load_dwordx4 v[84:87], v7, s[20:23], s53 offen offset:0 sc1
    v_mfma_f32_16x16x32_bf16 v[56:59], v[152:155], v[92:95], v[56:59]
    ds_read_b64_tr_b16 v[186:187], v12 offset:14592
    v_mfma_f32_16x16x32_bf16 v[28:31], v[156:159], v[88:91], v[28:31]
    ds_read_b64_tr_b16 v[188:189], v13 offset:12544
    v_mfma_f32_16x16x32_bf16 v[60:63], v[156:159], v[92:95], v[60:63]
    ds_read_b64_tr_b16 v[190:191], v13 offset:14592
    s_waitcnt vmcnt(13) lgkmcnt(8)
    v_mfma_f32_16x16x32_bf16 v[16:19], v[160:163], v[96:99], v[16:19]
    ds_read_b64_tr_b16 v[144:145], v12 offset:16384
    v_mfma_f32_16x16x32_bf16 v[48:51], v[160:163], v[100:103], v[48:51]
    ds_read_b64_tr_b16 v[146:147], v12 offset:18432
    buffer_load_dwordx4 v[88:91], v6, s[20:23], s53 offen offset:1024 sc1
    v_mfma_f32_16x16x32_bf16 v[20:23], v[164:167], v[96:99], v[20:23]
    ds_read_b64_tr_b16 v[148:149], v13 offset:16384
    v_mfma_f32_16x16x32_bf16 v[52:55], v[164:167], v[100:103], v[52:55]
    ds_read_b64_tr_b16 v[150:151], v13 offset:18432
    v_mfma_f32_16x16x32_bf16 v[24:27], v[168:171], v[96:99], v[24:27]
    ds_read_b64_tr_b16 v[152:153], v12 offset:16640
    buffer_load_dwordx4 v[92:95], v7, s[20:23], s53 offen offset:1024 sc1
    v_mfma_f32_16x16x32_bf16 v[56:59], v[168:171], v[100:103], v[56:59]
    ds_read_b64_tr_b16 v[154:155], v12 offset:18688
    v_mfma_f32_16x16x32_bf16 v[28:31], v[172:175], v[96:99], v[28:31]
    ds_read_b64_tr_b16 v[156:157], v13 offset:16640
    v_mfma_f32_16x16x32_bf16 v[60:63], v[172:175], v[100:103], v[60:63]
    ds_read_b64_tr_b16 v[158:159], v13 offset:18688
    s_waitcnt vmcnt(13) lgkmcnt(8)
    v_mfma_f32_16x16x32_bf16 v[16:19], v[176:179], v[104:107], v[16:19]
    ds_read_b64_tr_b16 v[160:161], v12 offset:20480
    v_mfma_f32_16x16x32_bf16 v[48:51], v[176:179], v[108:111], v[48:51]
    ds_read_b64_tr_b16 v[162:163], v12 offset:22528
    buffer_load_dwordx4 v[96:99], v6, s[20:23], s53 offen offset:2048 sc1
    v_mfma_f32_16x16x32_bf16 v[20:23], v[180:183], v[104:107], v[20:23]
    ds_read_b64_tr_b16 v[164:165], v13 offset:20480
    v_mfma_f32_16x16x32_bf16 v[52:55], v[180:183], v[108:111], v[52:55]
    ds_read_b64_tr_b16 v[166:167], v13 offset:22528
    v_mfma_f32_16x16x32_bf16 v[24:27], v[184:187], v[104:107], v[24:27]
    ds_read_b64_tr_b16 v[168:169], v12 offset:20736
    buffer_load_dwordx4 v[100:103], v7, s[20:23], s53 offen offset:2048 sc1
    v_mfma_f32_16x16x32_bf16 v[56:59], v[184:187], v[108:111], v[56:59]
    ds_read_b64_tr_b16 v[170:171], v12 offset:22784
    v_mfma_f32_16x16x32_bf16 v[28:31], v[188:191], v[104:107], v[28:31]
    ds_read_b64_tr_b16 v[172:173], v13 offset:20736
    v_mfma_f32_16x16x32_bf16 v[60:63], v[188:191], v[108:111], v[60:63]
    ds_read_b64_tr_b16 v[174:175], v13 offset:22784
    s_waitcnt vmcnt(13) lgkmcnt(8)
    v_mfma_f32_16x16x32_bf16 v[16:19], v[144:147], v[112:115], v[16:19]
    ds_read_b64_tr_b16 v[176:177], v12 offset:24576
    v_mfma_f32_16x16x32_bf16 v[48:51], v[144:147], v[116:119], v[48:51]
    ds_read_b64_tr_b16 v[178:179], v12 offset:26624
    buffer_load_dwordx4 v[104:107], v6, s[20:23], s53 offen offset:3072 sc1
    v_mfma_f32_16x16x32_bf16 v[20:23], v[148:151], v[112:115], v[20:23]
    ds_read_b64_tr_b16 v[180:181], v13 offset:24576
    v_mfma_f32_16x16x32_bf16 v[52:55], v[148:151], v[116:119], v[52:55]
    ds_read_b64_tr_b16 v[182:183], v13 offset:26624
    v_mfma_f32_16x16x32_bf16 v[24:27], v[152:155], v[112:115], v[24:27]
    ds_read_b64_tr_b16 v[184:185], v12 offset:24832
    buffer_load_dwordx4 v[108:111], v7, s[20:23], s53 offen offset:3072 sc1
    v_mfma_f32_16x16x32_bf16 v[56:59], v[152:155], v[116:119], v[56:59]
    ds_read_b64_tr_b16 v[186:187], v12 offset:26880
    v_mfma_f32_16x16x32_bf16 v[28:31], v[156:159], v[112:115], v[28:31]
    ds_read_b64_tr_b16 v[188:189], v13 offset:24832
    v_mfma_f32_16x16x32_bf16 v[60:63], v[156:159], v[116:119], v[60:63]
    ds_read_b64_tr_b16 v[190:191], v13 offset:26880
    s_waitcnt vmcnt(13) lgkmcnt(8)
    v_mfma_f32_16x16x32_bf16 v[16:19], v[160:163], v[120:123], v[16:19]
    ds_read_b64_tr_b16 v[144:145], v12 offset:28672
    s_mov_b32 s53, 20480
    v_mfma_f32_16x16x32_bf16 v[48:51], v[160:163], v[124:127], v[48:51]
    ds_read_b64_tr_b16 v[146:147], v12 offset:30720
    buffer_load_dwordx4 v[112:115], v6, s[20:23], s53 offen offset:0 sc1
    v_mfma_f32_16x16x32_bf16 v[20:23], v[164:167], v[120:123], v[20:23]
    ds_read_b64_tr_b16 v[148:149], v13 offset:28672
    v_mfma_f32_16x16x32_bf16 v[52:55], v[164:167], v[124:127], v[52:55]
    ds_read_b64_tr_b16 v[150:151], v13 offset:30720
    v_mfma_f32_16x16x32_bf16 v[24:27], v[168:171], v[120:123], v[24:27]
    ds_read_b64_tr_b16 v[152:153], v12 offset:28928
    buffer_load_dwordx4 v[116:119], v7, s[20:23], s53 offen offset:0 sc1
    v_mfma_f32_16x16x32_bf16 v[56:59], v[168:171], v[124:127], v[56:59]
    ds_read_b64_tr_b16 v[154:155], v12 offset:30976
    v_mfma_f32_16x16x32_bf16 v[28:31], v[172:175], v[120:123], v[28:31]
    ds_read_b64_tr_b16 v[156:157], v13 offset:28928
    v_mfma_f32_16x16x32_bf16 v[60:63], v[172:175], v[124:127], v[60:63]
    ds_read_b64_tr_b16 v[158:159], v13 offset:30976
    s_waitcnt vmcnt(10) lgkmcnt(8)
    v_cmp_ne_u32 vcc, 1, v246
    s_nop 4
    s_cbranch_vccnz LG_pp
LG_ppr:
    s_barrier
    v_add_u32 v12, 0xffff1000, v12
    v_add_u32 v13, 0xffff1000, v13
    v_mfma_f32_16x16x32_bf16 v[16:19], v[176:179], v[128:131], v[16:19]
    ds_read_b64_tr_b16 v[160:161], v12 offset:0
    v_mfma_f32_16x16x32_bf16 v[48:51], v[176:179], v[132:135], v[48:51]
    ds_read_b64_tr_b16 v[162:163], v12 offset:2048
    buffer_load_dwordx4 v[120:123], v6, s[20:23], s53 offen offset:1024 sc1
    v_mfma_f32_16x16x32_bf16 v[20:23], v[180:183], v[128:131], v[20:23]
    ds_read_b64_tr_b16 v[164:165], v13 offset:0
    v_mfma_f32_16x16x32_bf16 v[52:55], v[180:183], v[132:135], v[52:55]
    ds_read_b64_tr_b16 v[166:167], v13 offset:2048
    v_mfma_f32_16x16x32_bf16 v[24:27], v[184:187], v[128:131], v[24:27]
    ds_read_b64_tr_b16 v[168:169], v12 offset:256
    buffer_load_dwordx4 v[124:127], v7, s[20:23], s53 offen offset:1024 sc1
    v_mfma_f32_16x16x32_bf16 v[56:59], v[184:187], v[132:135], v[56:59]
    ds_read_b64_tr_b16 v[170:171], v12 offset:2304
    v_mfma_f32_16x16x32_bf16 v[28:31], v[188:191], v[128:131], v[28:31]
    ds_read_b64_tr_b16 v[172:173], v13 offset:256
    buffer_load_dwordx4 v[64:67], v5, s[24:27], s50 offen offset:0 sc1
    v_mfma_f32_16x16x32_bf16 v[60:63], v[188:191], v[132:135], v[60:63]
    ds_read_b64_tr_b16 v[174:175], v13 offset:2304
    s_waitcnt vmcnt(14) lgkmcnt(8)
    v_mfma_f32_16x16x32_bf16 v[16:19], v[144:147], v[136:139], v[16:19]
    ds_read_b64_tr_b16 v[176:177], v12 offset:4096
    v_mfma_f32_16x16x32_bf16 v[48:51], v[144:147], v[140:143], v[48:51]
    ds_read_b64_tr_b16 v[178:179], v12 offset:6144
    buffer_load_dwordx4 v[128:131], v6, s[20:23], s53 offen offset:2048 sc1
    v_mfma_f32_16x16x32_bf16 v[20:23], v[148:151], v[136:139], v[20:23]
    ds_read_b64_tr_b16 v[180:181], v13 offset:4096
    v_mfma_f32_16x16x32_bf16 v[52:55], v[148:151], v[140:143], v[52:55]
    ds_read_b64_tr_b16 v[182:183], v13 offset:6144
    v_mfma_f32_16x16x32_bf16 v[24:27], v[152:155], v[136:139], v[24:27]
    ds_read_b64_tr_b16 v[184:185], v12 offset:4352
    buffer_load_dwordx4 v[132:135], v7, s[20:23], s53 offen offset:2048 sc1
    v_mfma_f32_16x16x32_bf16 v[56:59], v[152:155], v[140:143], v[56:59]
    ds_read_b64_tr_b16 v[186:187], v12 offset:6400
    v_mfma_f32_16x16x32_bf16 v[28:31], v[156:159], v[136:139], v[28:31]
    ds_read_b64_tr_b16 v[188:189], v13 offset:4352
    buffer_load_dwordx4 v[68:71], v5, s[24:27], s50 offen offset:1024 sc1
    v_mfma_f32_16x16x32_bf16 v[60:63], v[156:159], v[140:143], v[60:63]
    ds_read_b64_tr_b16 v[190:191], v13 offset:6400
    s_waitcnt vmcnt(14) lgkmcnt(8)
    v_mfma_f32_16x16x32_bf16 v[16:19], v[160:163], v[80:83], v[16:19]
    ds_read_b64_tr_b16 v[144:145], v12 offset:8192
    v_mfma_f32_16x16x32_bf16 v[48:51], v[160:163], v[84:87], v[48:51]
    ds_read_b64_tr_b16 v[146:147], v12 offset:10240
    buffer_load_dwordx4 v[136:139], v6, s[20:23], s53 offen offset:3072 sc1
    v_mfma_f32_16x16x32_bf16 v[20:23], v[164:167], v[80:83], v[20:23]
    ds_read_b64_tr_b16 v[148:149], v13 offset:8192
    v_mfma_f32_16x16x32_bf16 v[52:55], v[164:167], v[84:87], v[52:55]
    ds_read_b64_tr_b16 v[150:151], v13 offset:10240
    v_mfma_f32_16x16x32_bf16 v[24:27], v[168:171], v[80:83], v[24:27]
    ds_read_b64_tr_b16 v[152:153], v12 offset:8448
    buffer_load_dwordx4 v[140:143], v7, s[20:23], s53 offen offset:3072 sc1
    v_mfma_f32_16x16x32_bf16 v[56:59], v[168:171], v[84:87], v[56:59]
    ds_read_b64_tr_b16 v[154:155], v12 offset:10496
    v_mfma_f32_16x16x32_bf16 v[28:31], v[172:175], v[80:83], v[28:31]
    ds_read_b64_tr_b16 v[156:157], v13 offset:8448
    buffer_load_dwordx4 v[72:75], v5, s[24:27], s50 offen offset:2048 sc1
    v_mfma_f32_16x16x32_bf16 v[60:63], v[172:175], v[84:87], v[60:63]
    ds_read_b64_tr_b16 v[158:159], v13 offset:10496
    s_waitcnt vmcnt(15) lgkmcnt(8)
    v_mfma_f32_16x16x32_bf16 v[16:19], v[176:179], v[88:91], v[16:19]
    ds_read_b64_tr_b16 v[160:161], v12 offset:12288
    s_mov_b32 s53, 24576
    v_mfma_f32_16x16x32_bf16 v[48:51], v[176:179], v[92:95], v[48:51]
    ds_read_b64_tr_b16 v[162:163], v12 offset:14336
    buffer_load_dwordx4 v[80:83], v6, s[20:23], s53 offen offset:0 sc1
    v_mfma_f32_16x16x32_bf16 v[20:23], v[180:183], v[88:91], v[20:23]
    ds_read_b64_tr_b16 v[164:165], v13 offset:12288
    v_mfma_f32_16x16x32_bf16 v[52:55], v[180:183], v[92:95], v[52:55]
    ds_read_b64_tr_b16 v[166:167], v13 offset:14336
    v_mfma_f32_16x16x32_bf16 v[24:27], v[184:187], v[88:91], v[24:27]
    ds_read_b64_tr_b16 v[168:169], v12 offset:12544
    buffer_load_dwordx4 v[84:87], v7, s[20:23], s53 offen offset:0 sc1
    v_mfma_f32_16x16x32_bf16 v[56:59], v[184:187], v[92:95], v[56:59]
    ds_read_b64_tr_b16 v[170:171], v12 offset:14592
    v_mfma_f32_16x16x32_bf16 v[28:31], v[188:191], v[88:91], v[28:31]
    ds_read_b64_tr_b16 v[172:173], v13 offset:12544
    buffer_load_dwordx4 v[76:79], v5, s[24:27], s50 offen offset:3072 sc1
    v_mfma_f32_16x16x32_bf16 v[60:63], v[188:191], v[92:95], v[60:63]
    ds_read_b64_tr_b16 v[174:175], v13 offset:14592
    s_waitcnt vmcnt(16) lgkmcnt(8)
    v_mfma_f32_16x16x32_bf16 v[16:19], v[144:147], v[96:99], v[16:19]
    ds_read_b64_tr_b16 v[176:177], v12 offset:16384
    v_mfma_f32_16x16x32_bf16 v[48:51], v[144:147], v[100:103], v[48:51]
    ds_read_b64_tr_b16 v[178:179], v12 offset:18432
    buffer_load_dwordx4 v[88:91], v6, s[20:23], s53 offen offset:1024 sc1
    v_mfma_f32_16x16x32_bf16 v[20:23], v[148:151], v[96:99], v[20:23]
    ds_read_b64_tr_b16 v[180:181], v13 offset:16384
    v_mfma_f32_16x16x32_bf16 v[52:55], v[148:151], v[100:103], v[52:55]
    ds_read_b64_tr_b16 v[182:183], v13 offset:18432
    v_mfma_f32_16x16x32_bf16 v[24:27], v[152:155], v[96:99], v[24:27]
    ds_read_b64_tr_b16 v[184:185], v12 offset:16640
    buffer_load_dwordx4 v[92:95], v7, s[20:23], s53 offen offset:1024 sc1
    v_mfma_f32_16x16x32_bf16 v[56:59], v[152:155], v[100:103], v[56:59]
    ds_read_b64_tr_b16 v[186:187], v12 offset:18688
    v_mfma_f32_16x16x32_bf16 v[28:31], v[156:159], v[96:99], v[28:31]
    ds_read_b64_tr_b16 v[188:189], v13 offset:16640
    v_mfma_f32_16x16x32_bf16 v[60:63], v[156:159], v[100:103], v[60:63]
    ds_read_b64_tr_b16 v[190:191], v13 offset:18688
    s_waitcnt vmcnt(16) lgkmcnt(8)
    v_mfma_f32_16x16x32_bf16 v[16:19], v[160:163], v[104:107], v[16:19]
    ds_read_b64_tr_b16 v[144:145], v12 offset:20480
    v_mfma_f32_16x16x32_bf16 v[48:51], v[160:163], v[108:111], v[48:51]
    ds_read_b64_tr_b16 v[146:147], v12 offset:22528
    buffer_load_dwordx4 v[96:99], v6, s[20:23], s53 offen offset:2048 sc1
    v_mfma_f32_16x16x32_bf16 v[20:23], v[164:167], v[104:107], v[20:23]
    ds_read_b64_tr_b16 v[148:149], v13 offset:20480
    v_mfma_f32_16x16x32_bf16 v[52:55], v[164:167], v[108:111], v[52:55]
    ds_read_b64_tr_b16 v[150:151], v13 offset:22528
    v_mfma_f32_16x16x32_bf16 v[24:27], v[168:171], v[104:107], v[24:27]
    ds_read_b64_tr_b16 v[152:153], v12 offset:20736
    buffer_load_dwordx4 v[100:103], v7, s[20:23], s53 offen offset:2048 sc1
    v_mfma_f32_16x16x32_bf16 v[56:59], v[168:171], v[108:111], v[56:59]
    ds_read_b64_tr_b16 v[154:155], v12 offset:22784
    v_mfma_f32_16x16x32_bf16 v[28:31], v[172:175], v[104:107], v[28:31]
    ds_read_b64_tr_b16 v[156:157], v13 offset:20736
    v_mfma_f32_16x16x32_bf16 v[60:63], v[172:175], v[108:111], v[60:63]
    ds_read_b64_tr_b16 v[158:159], v13 offset:22784
    s_waitcnt vmcnt(16) lgkmcnt(8)
    v_mfma_f32_16x16x32_bf16 v[16:19], v[176:179], v[112:115], v[16:19]
    ds_read_b64_tr_b16 v[160:161], v12 offset:24576
    v_mfma_f32_16x16x32_bf16 v[48:51], v[176:179], v[116:119], v[48:51]
    ds_read_b64_tr_b16 v[162:163], v12 offset:26624
    buffer_load_dwordx4 v[104:107], v6, s[20:23], s53 offen offset:3072 sc1
    v_mfma_f32_16x16x32_bf16 v[20:23], v[180:183], v[112:115], v[20:23]
    ds_read_b64_tr_b16 v[164:165], v13 offset:24576
    v_mfma_f32_16x16x32_bf16 v[52:55], v[180:183], v[116:119], v[52:55]
    ds_read_b64_tr_b16 v[166:167], v13 offset:26624
    v_mfma_f32_16x16x32_bf16 v[24:27], v[184:187], v[112:115], v[24:27]
    ds_read_b64_tr_b16 v[168:169], v12 offset:24832
    buffer_load_dwordx4 v[108:111], v7, s[20:23], s53 offen offset:3072 sc1
    v_mfma_f32_16x16x32_bf16 v[56:59], v[184:187], v[116:119], v[56:59]
    ds_read_b64_tr_b16 v[170:171], v12 offset:26880
    v_mfma_f32_16x16x32_bf16 v[28:31], v[188:191], v[112:115], v[28:31]
    ds_read_b64_tr_b16 v[172:173], v13 offset:24832
    v_mfma_f32_16x16x32_bf16 v[60:63], v[188:191], v[116:119], v[60:63]
    ds_read_b64_tr_b16 v[174:175], v13 offset:26880
    s_waitcnt vmcnt(16) lgkmcnt(8)
    v_mfma_f32_16x16x32_bf16 v[16:19], v[144:147], v[120:123], v[16:19]
    ds_read_b64_tr_b16 v[176:177], v12 offset:28672
    s_mov_b32 s53, 28672
    v_mfma_f32_16x16x32_bf16 v[48:51], v[144:147], v[124:127], v[48:51]
    ds_read_b64_tr_b16 v[178:179], v12 offset:30720
    buffer_load_dwordx4 v[112:115], v6, s[20:23], s53 offen offset:0 sc1
    v_mfma_f32_16x16x32_bf16 v[20:23], v[148:151], v[120:123], v[20:23]
    ds_read_b64_tr_b16 v[180:181], v13 offset:28672
    v_mfma_f32_16x16x32_bf16 v[52:55], v[148:151], v[124:127], v[52:55]
    ds_read_b64_tr_b16 v[182:183], v13 offset:30720
    v_mfma_f32_16x16x32_bf16 v[24:27], v[152:155], v[120:123], v[24:27]
    ds_read_b64_tr_b16 v[184:185], v12 offset:28928
    buffer_load_dwordx4 v[116:119], v7, s[20:23], s53 offen offset:0 sc1
    v_mfma_f32_16x16x32_bf16 v[56:59], v[152:155], v[124:127], v[56:59]
    ds_read_b64_tr_b16 v[186:187], v12 offset:30976
    v_mfma_f32_16x16x32_bf16 v[28:31], v[156:159], v[120:123], v[28:31]
    ds_read_b64_tr_b16 v[188:189], v13 offset:28928
    v_mfma_f32_16x16x32_bf16 v[60:63], v[156:159], v[124:127], v[60:63]
    ds_read_b64_tr_b16 v[190:191], v13 offset:30976
    s_waitcnt vmcnt(15) lgkmcnt(8)
    v_add_u32 v12, 0x8000, v12
    v_add_u32 v13, 0x8000, v13
    v_mfma_f32_16x16x32_bf16 v[16:19], v[160:163], v[128:131], v[16:19]
    ds_read_b64_tr_b16 v[144:145], v12 offset:0
    v_mfma_f32_16x16x32_bf16 v[48:51], v[160:163], v[132:135], v[48:51]
    ds_read_b64_tr_b16 v[146:147], v12 offset:2048
    buffer_load_dwordx4 v[120:123], v6, s[20:23], s53 offen offset:1024 sc1
    v_mfma_f32_16x16x32_bf16 v[20:23], v[164:167], v[128:131], v[20:23]
    ds_read_b64_tr_b16 v[148:149], v13 offset:0
    v_mfma_f32_16x16x32_bf16 v[52:55], v[164:167], v[132:135], v[52:55]
    ds_read_b64_tr_b16 v[150:151], v13 offset:2048
    v_mfma_f32_16x16x32_bf16 v[24:27], v[168:171], v[128:131], v[24:27]
    ds_read_b64_tr_b16 v[152:153], v12 offset:256
    buffer_load_dwordx4 v[124:127], v7, s[20:23], s53 offen offset:1024 sc1
    v_mfma_f32_16x16x32_bf16 v[56:59], v[168:171], v[132:135], v[56:59]
    ds_read_b64_tr_b16 v[154:155], v12 offset:2304
    v_mfma_f32_16x16x32_bf16 v[28:31], v[172:175], v[128:131], v[28:31]
    ds_read_b64_tr_b16 v[156:157], v13 offset:256
    v_mfma_f32_16x16x32_bf16 v[60:63], v[172:175], v[132:135], v[60:63]
    ds_read_b64_tr_b16 v[158:159], v13 offset:2304
    s_waitcnt vmcnt(14) lgkmcnt(8)
    v_mfma_f32_16x16x32_bf16 v[16:19], v[176:179], v[136:139], v[16:19]
    ds_read_b64_tr_b16 v[160:161], v12 offset:4096
    v_mfma_f32_16x16x32_bf16 v[48:51], v[176:179], v[140:143], v[48:51]
    ds_read_b64_tr_b16 v[162:163], v12 offset:6144
    buffer_load_dwordx4 v[128:131], v6, s[20:23], s53 offen offset:2048 sc1
    v_mfma_f32_16x16x32_bf16 v[20:23], v[180:183], v[136:139], v[20:23]
    ds_read_b64_tr_b16 v[164:165], v13 offset:4096
    v_mfma_f32_16x16x32_bf16 v[52:55], v[180:183], v[140:143], v[52:55]
    ds_read_b64_tr_b16 v[166:167], v13 offset:6144
    v_mfma_f32_16x16x32_bf16 v[24:27], v[184:187], v[136:139], v[24:27]
    ds_read_b64_tr_b16 v[168:169], v12 offset:4352
    buffer_load_dwordx4 v[132:135], v7, s[20:23], s53 offen offset:2048 sc1
    v_mfma_f32_16x16x32_bf16 v[56:59], v[184:187], v[140:143], v[56:59]
    ds_read_b64_tr_b16 v[170:171], v12 offset:6400
    v_mfma_f32_16x16x32_bf16 v[28:31], v[188:191], v[136:139], v[28:31]
    ds_read_b64_tr_b16 v[172:173], v13 offset:4352
    v_mfma_f32_16x16x32_bf16 v[60:63], v[188:191], v[140:143], v[60:63]
    ds_read_b64_tr_b16 v[174:175], v13 offset:6400
    s_waitcnt vmcnt(13) lgkmcnt(8)
    v_mfma_f32_16x16x32_bf16 v[16:19], v[144:147], v[80:83], v[16:19]
    ds_read_b64_tr_b16 v[176:177], v12 offset:8192
    v_mfma_f32_16x16x32_bf16 v[48:51], v[144:147], v[84:87], v[48:51]
    ds_read_b64_tr_b16 v[178:179], v12 offset:10240
    buffer_load_dwordx4 v[136:139], v6, s[20:23], s53 offen offset:3072 sc1
    v_mfma_f32_16x16x32_bf16 v[20:23], v[148:151], v[80:83], v[20:23]
    ds_read_b64_tr_b16 v[180:181], v13 offset:8192
    v_mfma_f32_16x16x32_bf16 v[52:55], v[148:151], v[84:87], v[52:55]
    ds_read_b64_tr_b16 v[182:183], v13 offset:10240
    v_mfma_f32_16x16x32_bf16 v[24:27], v[152:155], v[80:83], v[24:27]
    ds_read_b64_tr_b16 v[184:185], v12 offset:8448
    buffer_load_dwordx4 v[140:143], v7, s[20:23], s53 offen offset:3072 sc1
    v_mfma_f32_16x16x32_bf16 v[56:59], v[152:155], v[84:87], v[56:59]
    ds_read_b64_tr_b16 v[186:187], v12 offset:10496
    v_mfma_f32_16x16x32_bf16 v[28:31], v[156:159], v[80:83], v[28:31]
    ds_read_b64_tr_b16 v[188:189], v13 offset:8448
    v_mfma_f32_16x16x32_bf16 v[60:63], v[156:159], v[84:87], v[60:63]
    ds_read_b64_tr_b16 v[190:191], v13 offset:10496
    s_waitcnt vmcnt(12) lgkmcnt(8)
    v_mfma_f32_16x16x32_bf16 v[16:19], v[160:163], v[88:91], v[16:19]
    ds_read_b64_tr_b16 v[144:145], v12 offset:12288
    v_mfma_f32_16x16x32_bf16 v[48:51], v[160:163], v[92:95], v[48:51]
    ds_read_b64_tr_b16 v[146:147], v12 offset:14336
    v_mfma_f32_16x16x32_bf16 v[20:23], v[164:167], v[88:91], v[20:23]
    ds_read_b64_tr_b16 v[148:149], v13 offset:12288
    v_mfma_f32_16x16x32_bf16 v[52:55], v[164:167], v[92:95], v[52:55]
    ds_read_b64_tr_b16 v[150:151], v13 offset:14336
    v_mfma_f32_16x16x32_bf16 v[24:27], v[168:171], v[88:91], v[24:27]
    ds_read_b64_tr_b16 v[152:153], v12 offset:12544
    v_mfma_f32_16x16x32_bf16 v[56:59], v[168:171], v[92:95], v[56:59]
    ds_read_b64_tr_b16 v[154:155], v12 offset:14592
    v_mfma_f32_16x16x32_bf16 v[28:31], v[172:175], v[88:91], v[28:31]
    ds_read_b64_tr_b16 v[156:157], v13 offset:12544
    v_mfma_f32_16x16x32_bf16 v[60:63], v[172:175], v[92:95], v[60:63]
    ds_read_b64_tr_b16 v[158:159], v13 offset:14592
    s_waitcnt vmcnt(10) lgkmcnt(8)
    v_mfma_f32_16x16x32_bf16 v[16:19], v[176:179], v[96:99], v[16:19]
    ds_read_b64_tr_b16 v[160:161], v12 offset:16384
    v_lshlrev_b32 v228, 16, v76
    v_and_b32 v229, 0xffff0000, v76
    v_add_f32 v56, v56, v228
    v_add_f32 v57, v57, v229
    v_mfma_f32_16x16x32_bf16 v[48:51], v[176:179], v[100:103], v[48:51]
    ds_read_b64_tr_b16 v[162:163], v12 offset:18432
    v_lshlrev_b32 v232, 16, v70
    v_and_b32 v233, 0xffff0000, v70
    v_add_f32 v28, v28, v232
    v_add_f32 v29, v29, v233
    v_mfma_f32_16x16x32_bf16 v[20:23], v[180:183], v[96:99], v[20:23]
    ds_read_b64_tr_b16 v[164:165], v13 offset:16384
    v_lshlrev_b32 v232, 16, v78
    v_and_b32 v233, 0xffff0000, v78
    v_add_f32 v60, v60, v232
    v_add_f32 v61, v61, v233
    v_mfma_f32_16x16x32_bf16 v[52:55], v[180:183], v[100:103], v[52:55]
    ds_read_b64_tr_b16 v[166:167], v13 offset:18432
    v_lshlrev_b32 v228, 16, v64
    v_and_b32 v229, 0xffff0000, v64
    v_add_f32 v16, v16, v228
    v_add_f32 v17, v17, v229
    v_mfma_f32_16x16x32_bf16 v[24:27], v[184:187], v[96:99], v[24:27]
    ds_read_b64_tr_b16 v[168:169], v12 offset:16640
    v_lshlrev_b32 v228, 16, v72
    v_and_b32 v229, 0xffff0000, v72
    v_add_f32 v48, v48, v228
    v_add_f32 v49, v49, v229
    v_mfma_f32_16x16x32_bf16 v[56:59], v[184:187], v[100:103], v[56:59]
    ds_read_b64_tr_b16 v[170:171], v12 offset:18688
    v_lshlrev_b32 v232, 16, v66
    v_and_b32 v233, 0xffff0000, v66
    v_add_f32 v20, v20, v232
    v_add_f32 v21, v21, v233
    v_mfma_f32_16x16x32_bf16 v[28:31], v[188:191], v[96:99], v[28:31]
    ds_read_b64_tr_b16 v[172:173], v13 offset:16640
    v_lshlrev_b32 v232, 16, v74
    v_and_b32 v233, 0xffff0000, v74
    v_add_f32 v52, v52, v232
    v_add_f32 v53, v53, v233
    v_mfma_f32_16x16x32_bf16 v[60:63], v[188:191], v[100:103], v[60:63]
    ds_read_b64_tr_b16 v[174:175], v13 offset:18688
    v_lshlrev_b32 v228, 16, v68
    v_and_b32 v229, 0xffff0000, v68
    v_add_f32 v24, v24, v228
    v_add_f32 v25, v25, v229
    s_waitcnt vmcnt(8) lgkmcnt(8)
    v_mfma_f32_16x16x32_bf16 v[16:19], v[144:147], v[104:107], v[16:19]
    ds_read_b64_tr_b16 v[176:177], v12 offset:20480
    v_lshlrev_b32 v230, 16, v77
    v_and_b32 v231, 0xffff0000, v77
    v_add_f32 v58, v58, v230
    v_add_f32 v59, v59, v231
    v_mfma_f32_16x16x32_bf16 v[48:51], v[144:147], v[108:111], v[48:51]
    ds_read_b64_tr_b16 v[178:179], v12 offset:22528
    v_lshlrev_b32 v234, 16, v71
    v_and_b32 v235, 0xffff0000, v71
    v_add_f32 v30, v30, v234
    v_add_f32 v31, v31, v235
    v_mfma_f32_16x16x32_bf16 v[20:23], v[148:151], v[104:107], v[20:23]
    ds_read_b64_tr_b16 v[180:181], v13 offset:20480
    v_lshlrev_b32 v234, 16, v79
    v_and_b32 v235, 0xffff0000, v79
    v_add_f32 v62, v62, v234
    v_add_f32 v63, v63, v235
    v_mfma_f32_16x16x32_bf16 v[52:55], v[148:151], v[108:111], v[52:55]
    ds_read_b64_tr_b16 v[182:183], v13 offset:22528
    v_lshlrev_b32 v230, 16, v65
    v_and_b32 v231, 0xffff0000, v65
    v_add_f32 v18, v18, v230
    v_add_f32 v19, v19, v231
    v_mfma_f32_16x16x32_bf16 v[24:27], v[152:155], v[104:107], v[24:27]
    ds_read_b64_tr_b16 v[184:185], v12 offset:20736
    v_lshlrev_b32 v230, 16, v73
    v_and_b32 v231, 0xffff0000, v73
    v_add_f32 v50, v50, v230
    v_add_f32 v51, v51, v231
    v_mfma_f32_16x16x32_bf16 v[56:59], v[152:155], v[108:111], v[56:59]
    ds_read_b64_tr_b16 v[186:187], v12 offset:22784
    v_lshlrev_b32 v234, 16, v67
    v_and_b32 v235, 0xffff0000, v67
    v_add_f32 v22, v22, v234
    v_add_f32 v23, v23, v235
    v_mfma_f32_16x16x32_bf16 v[28:31], v[156:159], v[104:107], v[28:31]
    ds_read_b64_tr_b16 v[188:189], v13 offset:20736
    v_lshlrev_b32 v234, 16, v75
    v_and_b32 v235, 0xffff0000, v75
    v_add_f32 v54, v54, v234
    v_add_f32 v55, v55, v235
    v_mfma_f32_16x16x32_bf16 v[60:63], v[156:159], v[108:111], v[60:63]
    ds_read_b64_tr_b16 v[190:191], v13 offset:22784
    v_lshlrev_b32 v230, 16, v69
    v_and_b32 v231, 0xffff0000, v69
    v_add_f32 v26, v26, v230
    v_add_f32 v27, v27, v231
    s_waitcnt vmcnt(6) lgkmcnt(8)
    v_mfma_f32_16x16x32_bf16 v[16:19], v[160:163], v[112:115], v[16:19]
    ds_read_b64_tr_b16 v[144:145], v12 offset:24576
    v_mfma_f32_16x16x32_bf16 v[48:51], v[160:163], v[116:119], v[48:51]
    ds_read_b64_tr_b16 v[146:147], v12 offset:26624
    v_mfma_f32_16x16x32_bf16 v[20:23], v[164:167], v[112:115], v[20:23]
    ds_read_b64_tr_b16 v[148:149], v13 offset:24576
    v_mfma_f32_16x16x32_bf16 v[52:55], v[164:167], v[116:119], v[52:55]
    ds_read_b64_tr_b16 v[150:151], v13 offset:26624
    v_mfma_f32_16x16x32_bf16 v[24:27], v[168:171], v[112:115], v[24:27]
    ds_read_b64_tr_b16 v[152:153], v12 offset:24832
    v_mfma_f32_16x16x32_bf16 v[56:59], v[168:171], v[116:119], v[56:59]
    ds_read_b64_tr_b16 v[154:155], v12 offset:26880
    v_mfma_f32_16x16x32_bf16 v[28:31], v[172:175], v[112:115], v[28:31]
    ds_read_b64_tr_b16 v[156:157], v13 offset:24832
    v_mfma_f32_16x16x32_bf16 v[60:63], v[172:175], v[116:119], v[60:63]
    ds_read_b64_tr_b16 v[158:159], v13 offset:26880
    s_waitcnt vmcnt(4) lgkmcnt(8)
    v_mfma_f32_16x16x32_bf16 v[16:19], v[176:179], v[120:123], v[16:19]
    ds_read_b64_tr_b16 v[160:161], v247 offset:0
    v_mfma_f32_16x16x32_bf16 v[48:51], v[176:179], v[124:127], v[48:51]
    ds_read_b64_tr_b16 v[162:163], v247 offset:2048
    v_mfma_f32_16x16x32_bf16 v[20:23], v[180:183], v[120:123], v[20:23]
    ds_read_b64_tr_b16 v[164:165], v248 offset:0
    v_mfma_f32_16x16x32_bf16 v[52:55], v[180:183], v[124:127], v[52:55]
    ds_read_b64_tr_b16 v[166:167], v248 offset:2048
    v_mfma_f32_16x16x32_bf16 v[24:27], v[184:187], v[120:123], v[24:27]
    ds_read_b64_tr_b16 v[168:169], v247 offset:256
    v_mfma_f32_16x16x32_bf16 v[56:59], v[184:187], v[124:127], v[56:59]
    ds_read_b64_tr_b16 v[170:171], v247 offset:2304
    v_mfma_f32_16x16x32_bf16 v[28:31], v[188:191], v[120:123], v[28:31]
    ds_read_b64_tr_b16 v[172:173], v248 offset:256
    v_mfma_f32_16x16x32_bf16 v[60:63], v[188:191], v[124:127], v[60:63]
    ds_read_b64_tr_b16 v[174:175], v248 offset:2304
    s_waitcnt vmcnt(2) lgkmcnt(8)
    v_mfma_f32_16x16x32_bf16 v[16:19], v[144:147], v[128:131], v[16:19]
    v_mfma_f32_16x16x32_bf16 v[48:51], v[144:147], v[132:135], v[48:51]
    v_mfma_f32_16x16x32_bf16 v[20:23], v[148:151], v[128:131], v[20:23]
    v_mfma_f32_16x16x32_bf16 v[52:55], v[148:151], v[132:135], v[52:55]
    v_mfma_f32_16x16x32_bf16 v[24:27], v[152:155], v[128:131], v[24:27]
    v_mfma_f32_16x16x32_bf16 v[56:59], v[152:155], v[132:135], v[56:59]
    v_mfma_f32_16x16x32_bf16 v[28:31], v[156:159], v[128:131], v[28:31]
    v_mfma_f32_16x16x32_bf16 v[60:63], v[156:159], v[132:135], v[60:63]
    s_waitcnt vmcnt(0) lgkmcnt(0)
    v_mfma_f32_16x16x32_bf16 v[16:19], v[160:163], v[136:139], v[16:19]
    v_mfma_f32_16x16x32_bf16 v[48:51], v[160:163], v[140:143], v[48:51]
    v_mfma_f32_16x16x32_bf16 v[20:23], v[164:167], v[136:139], v[20:23]
    v_mfma_f32_16x16x32_bf16 v[52:55], v[164:167], v[140:143], v[52:55]
    v_mfma_f32_16x16x32_bf16 v[24:27], v[168:171], v[136:139], v[24:27]
    v_mfma_f32_16x16x32_bf16 v[56:59], v[168:171], v[140:143], v[56:59]
    v_mfma_f32_16x16x32_bf16 v[28:31], v[172:175], v[136:139], v[28:31]
    v_mfma_f32_16x16x32_bf16 v[60:63], v[172:175], v[140:143], v[60:63]
    v_lshrrev_b32 v6, 3, v1
    v_and_b32 v7, 7, v1
    v_lshlrev_b32 v7, 1, v7
    v_xor_b32 v7, v7, v6
    v_lshlrev_b32 v7, 4, v7
    v_lshl_add_u32 v6, v6, 8, v7
    v_add_u32 v6, s56, v6
    v_xor_b32 v7, 16, v6
    v_xor_b32 v12, 0x80, v6
    v_xor_b32 v13, 0x90, v6
    ds_write_b128 v8, v[16:19]
    ds_write_b128 v9, v[20:23]
    ds_write_b128 v10, v[24:27]
    ds_write_b128 v11, v[28:31]
    ds_read_b128 v[80:83], v6 offset:0
    ds_read_b128 v[84:87], v7 offset:0
    ds_read_b128 v[88:91], v12 offset:2048
    ds_read_b128 v[92:95], v13 offset:2048
    ds_write_b128 v8, v[48:51]
    ds_write_b128 v9, v[52:55]
    ds_write_b128 v10, v[56:59]
    ds_write_b128 v11, v[60:63]
    ds_read_b128 v[96:99], v6 offset:0
    ds_read_b128 v[100:103], v7 offset:0
    ds_read_b128 v[104:107], v12 offset:2048
    ds_read_b128 v[108:111], v13 offset:2048
    s_waitcnt lgkmcnt(10)
    v_pk_add_f32 v[80:81], v[80:81], v[32:33]
    v_pk_add_f32 v[82:83], v[82:83], v[34:35]
    v_pk_add_f32 v[84:85], v[84:85], v[36:37]
    v_pk_add_f32 v[86:87], v[86:87], v[38:39]
    v_cvt_pk_bf16_f32 v144, v80, v81
    v_cvt_pk_bf16_f32 v145, v82, v83
    v_cvt_pk_bf16_f32 v146, v84, v85
    v_cvt_pk_bf16_f32 v147, v86, v87
    s_add_u32 s55, s31, 0
    buffer_store_dwordx4 v[144:147], v14, s[64:67], s55 offen sc1
    s_waitcnt lgkmcnt(8)
    v_pk_add_f32 v[88:89], v[88:89], v[40:41]
    v_pk_add_f32 v[90:91], v[90:91], v[42:43]
    v_pk_add_f32 v[92:93], v[92:93], v[44:45]
    v_pk_add_f32 v[94:95], v[94:95], v[46:47]
    v_cvt_pk_bf16_f32 v148, v88, v89
    v_cvt_pk_bf16_f32 v149, v90, v91
    v_cvt_pk_bf16_f32 v150, v92, v93
    v_cvt_pk_bf16_f32 v151, v94, v95
    s_add_u32 s55, s31, 16384
    buffer_store_dwordx4 v[148:151], v14, s[64:67], s55 offen sc1
    s_waitcnt lgkmcnt(2)
    v_pk_add_f32 v[96:97], v[96:97], v[192:193]
    v_pk_add_f32 v[98:99], v[98:99], v[194:195]
    v_pk_add_f32 v[100:101], v[100:101], v[196:197]
    v_pk_add_f32 v[102:103], v[102:103], v[198:199]
    v_cvt_pk_bf16_f32 v152, v96, v97
    v_cvt_pk_bf16_f32 v153, v98, v99
    v_cvt_pk_bf16_f32 v154, v100, v101
    v_cvt_pk_bf16_f32 v155, v102, v103
    s_add_u32 s55, s31, 32768
    buffer_store_dwordx4 v[152:155], v14, s[64:67], s55 offen sc1
    s_waitcnt lgkmcnt(0)
    v_pk_add_f32 v[104:105], v[104:105], v[200:201]
    v_pk_add_f32 v[106:107], v[106:107], v[202:203]
    v_pk_add_f32 v[108:109], v[108:109], v[204:205]
    v_pk_add_f32 v[110:111], v[110:111], v[206:207]
    v_cvt_pk_bf16_f32 v156, v104, v105
    v_cvt_pk_bf16_f32 v157, v106, v107
    v_cvt_pk_bf16_f32 v158, v108, v109
    v_cvt_pk_bf16_f32 v159, v110, v111
    s_add_u32 s55, s31, 49152
    buffer_store_dwordx4 v[156:159], v14, s[64:67], s55 offen sc1
    s_endpgm
LG_sp0:
    s_setprio 2
    s_mov_b32 s3, 0
LG_spw0:
    ds_read_b32 v241, v255 offset:64
    s_add_u32 s3, s3, 1
    s_waitcnt lgkmcnt(0)
    v_cmp_gt_u32 vcc, v240, v241
    s_nop 4
    s_cbranch_vccz LG_spw0_ok
    s_sleep 1
    s_cmp_lt_u32 s3, 8000000
    s_cbranch_scc1 LG_spw0
LG_spw0_ok:
    s_setprio 0
    s_branch LG_spr0
LG_so1:
    s_mov_b32 s16, s4
    s_mov_b32 s17, s5
    s_mov_b32 s18, 0x200000
    s_mov_b32 s54, s62
    s_add_u32 s62, s62, 0x80000
    s_movk_i32 s57, 0x4000
    s_mov_b32 s22, 0
    s_setprio 2
    v_mov_b32 v8, v10
    v_mov_b32 v9, v10
    s_setprio 0
    s_cmp_ge_u32 s59, 16
    s_cbranch_scc1 LG_sg1
    s_add_u32 s55, s31, 0
    buffer_load_dwordx4 v[208:211], v14, s[64:67], s55 offen
    s_add_u32 s55, s31, 16384
    buffer_load_dwordx4 v[212:215], v14, s[64:67], s55 offen
    s_add_u32 s55, s31, 32768
    buffer_load_dwordx4 v[216:219], v14, s[64:67], s55 offen
    s_add_u32 s55, s31, 49152
    buffer_load_dwordx4 v[220:223], v14, s[64:67], s55 offen
    buffer_load_dwordx4 v[224:227], v15, s[32:35], s45 offen
    s_lshl_b32 s60, s40, 13
    s_add_u32 s60, s60, 32768
    s_add_u32 s55, s54, 0x180000
    s_add_u32 m0, s60, 0
    s_nop 0
    buffer_load_dwordx4 v10, s[16:19], s55 offen lds
    s_add_u32 s55, s55, 0x4000
    s_add_u32 m0, s60, 1024
    s_nop 0
    buffer_load_dwordx4 v10, s[16:19], s55 offen lds
    s_add_u32 s55, s55, 0x4000
    s_add_u32 m0, s60, 2048
    s_nop 0
    buffer_load_dwordx4 v10, s[16:19], s55 offen lds
    s_add_u32 s55, s55, 0x4000
    s_add_u32 m0, s60, 3072
    s_nop 0
    buffer_load_dwordx4 v10, s[16:19], s55 offen lds
    s_add_u32 s55, s55, 0x4000
    s_cmp_eq_u32 s40, 3
    s_cbranch_scc1 LG_sg1
    s_add_u32 m0, s60, 4096
    s_nop 0
    buffer_load_dwordx4 v10, s[16:19], s55 offen lds
    s_add_u32 s55, s55, 0x4000
    s_add_u32 m0, s60, 5120
    s_nop 0
    buffer_load_dwordx4 v10, s[16:19], s55 offen lds
    s_add_u32 s55, s55, 0x4000
    s_add_u32 m0, s60, 6144
    s_nop 0
    buffer_load_dwordx4 v10, s[16:19], s55 offen lds
    s_add_u32 s55, s55, 0x4000
    s_add_u32 m0, s60, 7168
    s_nop 0
    buffer_load_dwordx4 v10, s[16:19], s55 offen lds
    s_add_u32 s55, s55, 0x4000
    s_branch LG_sg1
LG_sp1:
    s_setprio 2
    s_mov_b32 s3, 0
LG_spw1:
    ds_read_b32 v241, v255 offset:64
    s_add_u32 s3, s3, 1
    s_waitcnt lgkmcnt(0)
    v_cmp_gt_u32 vcc, v240, v241
    s_nop 4
    s_cbranch_vccz LG_spw1_ok
    s_sleep 1
    s_cmp_lt_u32 s3, 8000000
    s_cbranch_scc1 LG_spw1
LG_spw1_ok:
    s_setprio 0
    s_branch LG_spr1
LG_so2:
    s_mov_b32 s16, s4
    s_mov_b32 s17, s5
    s_mov_b32 s18, 0x200000
    s_mov_b32 s54, s62
    s_add_u32 s62, s62, 0x80000
    s_movk_i32 s57, 0x4000
    s_mov_b32 s22, 0
    s_setprio 2
    v_mov_b32 v8, v10
    v_mov_b32 v9, v10
    s_setprio 0
    s_cmp_ge_u32 s59, 16
    s_cbranch_scc1 LG_sg2
    s_add_u32 s55, s31, 0
    buffer_load_dwordx4 v[208:211], v14, s[64:67], s55 offen
    s_add_u32 s55, s31, 16384
    buffer_load_dwordx4 v[212:215], v14, s[64:67], s55 offen
    s_add_u32 s55, s31, 32768
    buffer_load_dwordx4 v[216:219], v14, s[64:67], s55 offen
    s_add_u32 s55, s31, 49152
    buffer_load_dwordx4 v[220:223], v14, s[64:67], s55 offen
    buffer_load_dwordx4 v[224:227], v15, s[32:35], s45 offen
    s_lshl_b32 s60, s40, 13
    s_add_u32 s60, s60, 32768
    s_add_u32 s55, s54, 0x180000
    s_add_u32 m0, s60, 0
    s_nop 0
    buffer_load_dwordx4 v10, s[16:19], s55 offen lds
    s_add_u32 s55, s55, 0x4000
    s_add_u32 m0, s60, 1024
    s_nop 0
    buffer_load_dwordx4 v10, s[16:19], s55 offen lds
    s_add_u32 s55, s55, 0x4000
    s_add_u32 m0, s60, 2048
    s_nop 0
    buffer_load_dwordx4 v10, s[16:19], s55 offen lds
    s_add_u32 s55, s55, 0x4000
    s_add_u32 m0, s60, 3072
    s_nop 0
    buffer_load_dwordx4 v10, s[16:19], s55 offen lds
    s_add_u32 s55, s55, 0x4000
    s_cmp_eq_u32 s40, 3
    s_cbranch_scc1 LG_sg2
    s_add_u32 m0, s60, 4096
    s_nop 0
    buffer_load_dwordx4 v10, s[16:19], s55 offen lds
    s_add_u32 s55, s55, 0x4000
    s_add_u32 m0, s60, 5120
    s_nop 0
    buffer_load_dwordx4 v10, s[16:19], s55 offen lds
    s_add_u32 s55, s55, 0x4000
    s_add_u32 m0, s60, 6144
    s_nop 0
    buffer_load_dwordx4 v10, s[16:19], s55 offen lds
    s_add_u32 s55, s55, 0x4000
    s_add_u32 m0, s60, 7168
    s_nop 0
    buffer_load_dwordx4 v10, s[16:19], s55 offen lds
    s_add_u32 s55, s55, 0x4000
    s_branch LG_sg2
LG_pp:
    s_mov_b32 s58, 0
LG_p3:
    buffer_load_dword v246, v244, s[24:27], s36 offen sc1
    s_add_u32 s58, s58, 1
    s_waitcnt vmcnt(0)
    v_cmp_ne_u32 vcc, 1, v246
    s_nop 4
    s_cbranch_vccz LG_p3_ok
    s_sleep 4
    s_cmp_lt_u32 s58, 1000000
    s_cbranch_scc1 LG_p3
LG_p3_ok:
    s_branch LG_ppr
.section .rodata,"a"
.p2align 6
.amdhsa_kernel parallel_sum__grouped_kv_mqa__mixer_channel_mlp__prompt_kernel
  .amdhsa_next_free_vgpr 256
  .amdhsa_next_free_sgpr 96
  .amdhsa_accum_offset 256
  .amdhsa_group_segment_fixed_size 0
  .amdhsa_kernarg_size 104
  .amdhsa_user_sgpr_count 2
  .amdhsa_user_sgpr_kernarg_segment_ptr 1
  .amdhsa_system_sgpr_workgroup_id_x 1
  .amdhsa_float_denorm_mode_32 3
  .amdhsa_float_denorm_mode_16_64 3
.end_amdhsa_kernel
.text
Lcode_end:
```
